```python
import torch

def _softmax(x, axis=-1):
    return torch.softmax(x, dim=axis)
def _gelu(x):
    return torch.nn.functional.gelu(x, approximate="tanh")
def _silu(x):
    return torch.nn.functional.silu(x)
def _sigmoid(x):
    return torch.sigmoid(x)
def _layernorm(x, axis=-1, eps=1e-5):
    m = x.mean(dim=axis, keepdim=True)
    v = x.var(dim=axis, keepdim=True, unbiased=False)
    return (x - m) / torch.sqrt(v + eps)
def _scatter_add(tgt, idx, src, axis=0):
    return tgt.clone().index_add_(axis, idx, src)
def _segment_sum(src, seg, n):
    out = torch.zeros((n,) + src.shape[1:], dtype=src.dtype)
    return out.index_add_(0, seg, src)
def _pad(x, pw):
    flat = tuple(v for pair in reversed(pw) for v in pair)
    return torch.nn.functional.pad(x, flat)

kernel_name = 'standalone__gqa_block_cached__decode'

def setup_inputs():

    _w = (lambda a: (lambda t: t.to(torch.bfloat16) if t.is_floating_point() else t)(torch.as_tensor(a)))
    B, Sq, D = 4, 1, 576
    Hq, Hkv, Sk, Dh = 32, 16, 8192, 128
    assert Hq % Hkv == 0, (Hq, Hkv)
    return {
        "x": _w((lambda *s: torch.randn(*s, dtype=torch.bfloat16) * 0.8)(B, Sq, D)),
        "k_cache": _w((lambda *s: torch.randn(*s, dtype=torch.bfloat16) * 0.8)(B, Hkv, Sk, Dh)),
        "v_cache": _w((lambda *s: torch.randn(*s, dtype=torch.bfloat16) * 0.05)(B, Hkv, Sk, Dh)),
        "wq": _w((lambda *s: torch.randn(*s, dtype=torch.bfloat16) * 0.8)(D, Hq * Dh) * (D ** -0.5)),
        "wo": _w((lambda *s: torch.randn(*s, dtype=torch.bfloat16) * 0.05)(Hq * Dh, D) * ((Hq * Dh) ** -0.5)),
    }

def reference(x, k_cache, v_cache, wq, wo):
    B, Sq, D = x.shape
    Hq, Dh = 32, 128
    Hkv = k_cache.shape[1]
    rep = Hq // Hkv
    q = (lambda x, *d: x.permute(*d))((x @ wq).reshape(B, Sq, Hq, Dh), 0, 2, 1, 3)
    k = (lambda x, n, axis: torch.repeat_interleave(x, n, dim=axis))(k_cache, rep, axis=1)
    v = (lambda x, n, axis: torch.repeat_interleave(x, n, dim=axis))(v_cache, rep, axis=1)
    scores = torch.einsum("bhqd,bhkd->bhqk", q, k) * (Dh ** -0.5)
    p = _softmax(scores, axis=-1)
    o = torch.einsum("bhqk,bhkd->bhqd", p, v)
    return (lambda x, *d: x.permute(*d))(o, 0, 2, 1, 3).reshape(B, Sq, Hq * Dh) @ wo
```

```asm
; @launch grid=(256,1,1) block=(384,1,1) lds=60416
.amdgcn_target "amdgcn-amd-amdhsa--gfx950"
.text
.globl standalone__gqa_block_cached__decode_kernel
.p2align 12
.p2align 8
.type standalone__gqa_block_cached__decode_kernel,@function
standalone__gqa_block_cached__decode_kernel:
    s_cmp_ge_u32 s2, 256
    s_cbranch_scc1 L_end
    s_load_dwordx16 s[4:19], s[0:1], 0
    v_lshrrev_b32 v1, 6, v0
    v_and_b32 v0, 63, v0
    v_readfirstlane_b32 s3, v1
    s_and_b32 s32, s2, 15
    s_lshl_b32 s32, s32, 2
    s_bfe_u32 s31, s2, 0x20004
    s_or_b32 s32, s32, s31
    s_and_b32 s31, s2, 0xc0
    s_or_b32 s32, s32, s31
    s_cmp_eq_u32 s3, 4
    s_cbranch_scc1 L_helper
    s_cmp_eq_u32 s3, 5
    s_cbranch_scc1 L_balancer
    v_lshlrev_b32 v2, 4, v0
    s_and_b32 s31, s32, 3
    s_mul_i32 s31, s31, 16384
    s_lshl_b32 s33, s3, 12
    s_add_u32 s33, s33, s31
    s_mov_b32 s28, s33
    s_lshr_b32 s31, s32, 2
    s_lshl_b32 s31, s31, 21
    s_setprio 3
    s_waitcnt lgkmcnt(0)
    s_add_u32 s24, s8, s31
    s_addc_u32 s25, s9, 0
    s_mov_b32 s26, 0x200000
    s_mov_b32 s27, 0x20000
    buffer_load_dwordx4 v[184:187], v2, s[24:27], s33 offen offset:0 nt
    buffer_load_dwordx4 v[188:191], v2, s[24:27], s33 offen offset:1024 nt
    buffer_load_dwordx4 v[192:195], v2, s[24:27], s33 offen offset:2048 nt
    buffer_load_dwordx4 v[196:199], v2, s[24:27], s33 offen offset:3072 nt
    s_add_u32 s33, s33, 0x10000
    buffer_load_dwordx4 v[200:203], v2, s[24:27], s33 offen offset:0 nt
    s_load_dword s34, s[18:19], 0
    s_add_u32 s20, s6, s31
    s_addc_u32 s21, s7, 0
    s_mov_b32 s22, 0x200000
    s_mov_b32 s23, 0x20000
    v_lshrrev_b32 v3, 4, v0
    v_bfe_u32 v4, v0, 2, 2
    v_and_b32 v5, 3, v0
    v_lshlrev_b32 v3, 6, v3
    v_lshlrev_b32 v4, 8, v4
    v_lshlrev_b32 v5, 4, v5
    v_add3_u32 v1, v3, v4, v5
    s_mov_b32 s30, 0x3e0293ee
    v_lshrrev_b32 v3, 3, v0
    v_xor_b32 v3, v3, v0
    v_and_b32 v3, 1, v3
    v_lshlrev_b32 v3, 4, v3
    v_mov_b32 v4, 0xffff
    v_lshlrev_b32 v3, v3, v4
    v_bfe_u32 v4, v0, 1, 2
    v_cmp_eq_u32 vcc, 0, v4
    s_nop 1
    v_cndmask_b32 v28, 0, v3, vcc
    v_cmp_eq_u32 vcc, 1, v4
    s_nop 1
    v_cndmask_b32 v29, 0, v3, vcc
    v_cmp_eq_u32 vcc, 2, v4
    s_nop 1
    v_cndmask_b32 v30, 0, v3, vcc
    v_cmp_eq_u32 vcc, 3, v4
    s_nop 1
    v_cndmask_b32 v31, 0, v3, vcc
    v_and_b32 v3, 1, v0
    v_lshlrev_b32 v3, 8, v3
    v_lshrrev_b32 v4, 2, v0
    v_lshl_add_u32 v38, v4, 4, v3
    v_and_b32 v3, 2, v0
    v_cmp_ne_u32 vcc, 0, v3
    s_waitcnt vmcnt(4)
    buffer_load_dwordx4 v[204:207], v2, s[24:27], s33 offen offset:1024 nt
    s_waitcnt vmcnt(4)
    buffer_load_dwordx4 v[208:211], v2, s[24:27], s33 offen offset:2048 nt
    s_waitcnt vmcnt(4)
    buffer_load_dwordx4 v[212:215], v2, s[24:27], s33 offen offset:3072 nt
    s_add_u32 s33, s33, 0x10000
    s_waitcnt vmcnt(4)
    buffer_load_dwordx4 v[216:219], v2, s[24:27], s33 offen offset:0 nt
    s_waitcnt vmcnt(4)
    buffer_load_dwordx4 v[220:223], v2, s[24:27], s33 offen offset:1024 nt
    s_waitcnt vmcnt(4)
    buffer_load_dwordx4 v[224:227], v2, s[24:27], s33 offen offset:2048 nt
    s_waitcnt vmcnt(4)
    buffer_load_dwordx4 v[228:231], v2, s[24:27], s33 offen offset:3072 nt
    s_add_u32 s33, s33, 0x10000
    s_waitcnt vmcnt(4)
    buffer_load_dwordx4 v[232:235], v2, s[24:27], s33 offen offset:0 nt
    s_waitcnt vmcnt(4)
    buffer_load_dwordx4 v[236:239], v2, s[24:27], s33 offen offset:1024 nt
    s_waitcnt vmcnt(4)
    buffer_load_dwordx4 v[240:243], v2, s[24:27], s33 offen offset:2048 nt
    s_waitcnt vmcnt(4)
    buffer_load_dwordx4 v[244:247], v2, s[24:27], s33 offen offset:3072 nt
    s_add_u32 s33, s33, 0x10000
    s_waitcnt vmcnt(4)
    buffer_load_dwordx4 v[56:59], v1, s[20:23], s28 offen offset:0 nt
    s_waitcnt vmcnt(4)
    buffer_load_dwordx4 v[60:63], v1, s[20:23], s28 offen offset:1024 nt
    s_waitcnt vmcnt(4)
    buffer_load_dwordx4 v[64:67], v1, s[20:23], s28 offen offset:2048 nt
    s_waitcnt vmcnt(4)
    buffer_load_dwordx4 v[68:71], v1, s[20:23], s28 offen offset:3072 nt
    s_add_u32 s28, s28, 0x10000
    s_waitcnt vmcnt(4)
    buffer_load_dwordx4 v[72:75], v1, s[20:23], s28 offen offset:0 nt
    s_waitcnt vmcnt(4)
    buffer_load_dwordx4 v[76:79], v1, s[20:23], s28 offen offset:1024 nt
    s_waitcnt vmcnt(4)
    buffer_load_dwordx4 v[80:83], v1, s[20:23], s28 offen offset:2048 nt
    s_waitcnt vmcnt(4)
    buffer_load_dwordx4 v[84:87], v1, s[20:23], s28 offen offset:3072 nt
    s_add_u32 s28, s28, 0x10000
    s_waitcnt vmcnt(4)
    buffer_load_dwordx4 v[88:91], v1, s[20:23], s28 offen offset:0 nt
    s_waitcnt vmcnt(4)
    buffer_load_dwordx4 v[92:95], v1, s[20:23], s28 offen offset:1024 nt
    s_waitcnt vmcnt(4)
    buffer_load_dwordx4 v[96:99], v1, s[20:23], s28 offen offset:2048 nt
    s_waitcnt vmcnt(4)
    buffer_load_dwordx4 v[100:103], v1, s[20:23], s28 offen offset:3072 nt
    s_add_u32 s28, s28, 0x10000
    s_waitcnt vmcnt(4)
    buffer_load_dwordx4 v[104:107], v1, s[20:23], s28 offen offset:0 nt
    s_waitcnt vmcnt(4)
    buffer_load_dwordx4 v[108:111], v1, s[20:23], s28 offen offset:1024 nt
    s_waitcnt vmcnt(4)
    buffer_load_dwordx4 v[112:115], v1, s[20:23], s28 offen offset:2048 nt
    s_waitcnt vmcnt(4)
    buffer_load_dwordx4 v[116:119], v1, s[20:23], s28 offen offset:3072 nt
    s_add_u32 s28, s28, 0x10000
    s_waitcnt vmcnt(4)
    buffer_load_dwordx4 v[120:123], v1, s[20:23], s28 offen offset:0 nt
    s_waitcnt vmcnt(4)
    buffer_load_dwordx4 v[124:127], v1, s[20:23], s28 offen offset:1024 nt
    s_waitcnt vmcnt(4)
    buffer_load_dwordx4 v[128:131], v1, s[20:23], s28 offen offset:2048 nt
    s_waitcnt vmcnt(4)
    buffer_load_dwordx4 v[132:135], v1, s[20:23], s28 offen offset:3072 nt
    s_add_u32 s28, s28, 0x10000
    s_waitcnt vmcnt(4)
    buffer_load_dwordx4 v[136:139], v1, s[20:23], s28 offen offset:0 nt
    s_waitcnt vmcnt(4)
    buffer_load_dwordx4 v[140:143], v1, s[20:23], s28 offen offset:1024 nt
    s_waitcnt vmcnt(4)
    buffer_load_dwordx4 v[144:147], v1, s[20:23], s28 offen offset:2048 nt
    s_waitcnt vmcnt(4)
    buffer_load_dwordx4 v[148:151], v1, s[20:23], s28 offen offset:3072 nt
    s_add_u32 s28, s28, 0x10000
    s_waitcnt vmcnt(4)
    buffer_load_dwordx4 v[152:155], v1, s[20:23], s28 offen offset:0 nt
    s_waitcnt vmcnt(4)
    buffer_load_dwordx4 v[156:159], v1, s[20:23], s28 offen offset:1024 nt
    s_waitcnt vmcnt(4)
    buffer_load_dwordx4 v[160:163], v1, s[20:23], s28 offen offset:2048 nt
    s_waitcnt vmcnt(4)
    buffer_load_dwordx4 v[164:167], v1, s[20:23], s28 offen offset:3072 nt
    s_add_u32 s28, s28, 0x10000
    s_waitcnt vmcnt(4)
    buffer_load_dwordx4 v[168:171], v1, s[20:23], s28 offen offset:0 nt
    s_waitcnt vmcnt(4)
    buffer_load_dwordx4 v[172:175], v1, s[20:23], s28 offen offset:1024 nt
    s_waitcnt vmcnt(5)
    buffer_load_dwordx4 v[176:179], v1, s[20:23], s28 offen offset:2048 nt
    s_waitcnt vmcnt(6)
    buffer_load_dwordx4 v[180:183], v1, s[20:23], s28 offen offset:3072 nt
    s_add_u32 s28, s28, 0x10000
    s_barrier
    ds_read_b128 v[12:15], v38 offset:53248
    s_mov_b32 s29, 0
    s_waitcnt lgkmcnt(0) vmcnt(5)
    s_add_u32 s34, s34, 0x7f4a7c15
    v_cndmask_b32 v8, 0, v12, vcc
    v_cndmask_b32 v4, v12, 0, vcc
    v_cndmask_b32 v9, 0, v13, vcc
    v_cndmask_b32 v5, v13, 0, vcc
    v_cndmask_b32 v10, 0, v14, vcc
    v_cndmask_b32 v6, v14, 0, vcc
    v_cndmask_b32 v11, 0, v15, vcc
    v_cndmask_b32 v7, v15, 0, vcc
    s_nop 1
    s_mov_b64 vcc, 0
    s_mov_b64 s[92:93], 0
    v_mov_b32 v22, 48
    v_lshlrev_b32 v3, 2, v0
    s_lshl_b32 s31, s3, 8
    v_add_u32 v3, s31, v3
.p2align 3
L_kloop:
    v_mfma_f32_16x16x32_bf16 v[12:15], v[56:59], v[4:7], 0
    s_cbranch_vccnz L_dg1
    s_waitcnt vmcnt(4)
    s_cmp_eq_u32 s92, 0
    s_cbranch_scc1 L_dg1
    s_waitcnt vmcnt(3)
L_dg1:
    s_waitcnt vmcnt(9)
    buffer_load_dwordx4 v[56:59], v1, s[20:23], s28 offen offset:0 nt
    v_mfma_f32_16x16x32_bf16 v[12:15], v[60:63], v[8:11], v[12:15]
    v_add_f32_dpp v20, v16, v19 row_ror:12 row_mask:0xf bank_mask:0xf
    v_add_f32_dpp v20, v17, v20 row_ror:8 row_mask:0xf bank_mask:0xf
    v_add_f32_dpp v55, v18, v20 row_ror:4 row_mask:0xf bank_mask:0x8
    v_mov_b32 v40, v44
    v_mov_b32 v41, v45
    v_mov_b32 v42, v46
    v_mov_b32 v43, v47
    v_mov_b32 v44, v48
    v_mov_b32 v45, v49
    v_mov_b32 v46, v50
    v_mov_b32 v47, v51
    v_mov_b32 v48, v52
    v_mov_b32 v49, v53
    v_mov_b32 v50, v54
    v_mov_b32 v51, v55
    s_cbranch_vccnz L_dg2
    s_waitcnt vmcnt(4)
    s_cmp_eq_u32 s92, 0
    s_cbranch_scc1 L_dg2
    s_waitcnt vmcnt(3)
L_dg2:
    s_waitcnt vmcnt(9)
    buffer_load_dwordx4 v[60:63], v1, s[20:23], s28 offen offset:1024 nt
    v_add_u32 v22, 4, v22
    ds_write_b32 v3, v22 offset:58368
    ds_read_b32 v23, v3 offset:59392
    v_mfma_f32_16x16x32_bf16 v[16:19], v[64:67], v[4:7], 0
    s_cbranch_vccnz L_dg3
    s_waitcnt vmcnt(4)
    s_cmp_eq_u32 s92, 0
    s_cbranch_scc1 L_dg3
    s_waitcnt vmcnt(3)
L_dg3:
    s_waitcnt vmcnt(9)
    buffer_load_dwordx4 v[64:67], v1, s[20:23], s28 offen offset:2048 nt
    s_waitcnt lgkmcnt(0)
    v_cmp_gt_u32 vcc, v23, v22
    v_sub_u32 v23, v22, v23
    v_add_u32 v23, -9, v23
    v_cmp_gt_u32 s[92:93], 32, v23
    v_mfma_f32_16x16x32_bf16 v[16:19], v[68:71], v[8:11], v[16:19]
    v_add_f32_dpp v20, v13, v12 row_ror:12 row_mask:0xf bank_mask:0xf
    v_add_f32_dpp v20, v14, v20 row_ror:8 row_mask:0xf bank_mask:0xf
    v_add_f32_dpp v52, v15, v20 row_ror:4 row_mask:0xf bank_mask:0x1
    s_cbranch_vccnz L_dg4
    s_waitcnt vmcnt(4)
    s_cmp_eq_u32 s92, 0
    s_cbranch_scc1 L_dg4
    s_waitcnt vmcnt(3)
L_dg4:
    s_waitcnt vmcnt(9)
    buffer_load_dwordx4 v[68:71], v1, s[20:23], s28 offen offset:3072 nt
    s_add_u32 s28, s28, 0x10000
    v_mfma_f32_16x16x32_bf16 v[12:15], v[72:75], v[4:7], 0
    s_cbranch_vccnz L_dg5
    s_waitcnt vmcnt(4)
    s_cmp_eq_u32 s92, 0
    s_cbranch_scc1 L_dg5
    s_waitcnt vmcnt(3)
L_dg5:
    s_waitcnt vmcnt(9)
    buffer_load_dwordx4 v[72:75], v1, s[20:23], s28 offen offset:0 nt
    v_mfma_f32_16x16x32_bf16 v[12:15], v[76:79], v[8:11], v[12:15]
    v_add_f32_dpp v20, v18, v17 row_ror:12 row_mask:0xf bank_mask:0xf
    v_add_f32_dpp v20, v19, v20 row_ror:8 row_mask:0xf bank_mask:0xf
    v_add_f32_dpp v52, v16, v20 row_ror:4 row_mask:0xf bank_mask:0x2
    s_cbranch_vccnz L_dg6
    s_waitcnt vmcnt(4)
    s_cmp_eq_u32 s92, 0
    s_cbranch_scc1 L_dg6
    s_waitcnt vmcnt(3)
L_dg6:
    s_waitcnt vmcnt(9)
    buffer_load_dwordx4 v[76:79], v1, s[20:23], s28 offen offset:1024 nt
    v_add_u32 v22, 4, v22
    ds_write_b32 v3, v22 offset:58368
    ds_read_b32 v23, v3 offset:59392
    v_mfma_f32_16x16x32_bf16 v[16:19], v[80:83], v[4:7], 0
    s_cbranch_vccnz L_dg7
    s_waitcnt vmcnt(4)
    s_cmp_eq_u32 s92, 0
    s_cbranch_scc1 L_dg7
    s_waitcnt vmcnt(3)
L_dg7:
    s_waitcnt vmcnt(9)
    buffer_load_dwordx4 v[80:83], v1, s[20:23], s28 offen offset:2048 nt
    s_waitcnt lgkmcnt(0)
    v_cmp_gt_u32 vcc, v23, v22
    v_sub_u32 v23, v22, v23
    v_add_u32 v23, -9, v23
    v_cmp_gt_u32 s[92:93], 32, v23
    v_mfma_f32_16x16x32_bf16 v[16:19], v[84:87], v[8:11], v[16:19]
    v_add_f32_dpp v20, v15, v14 row_ror:12 row_mask:0xf bank_mask:0xf
    v_add_f32_dpp v20, v12, v20 row_ror:8 row_mask:0xf bank_mask:0xf
    v_add_f32_dpp v52, v13, v20 row_ror:4 row_mask:0xf bank_mask:0x4
    s_cbranch_vccnz L_dg8
    s_waitcnt vmcnt(4)
    s_cmp_eq_u32 s92, 0
    s_cbranch_scc1 L_dg8
    s_waitcnt vmcnt(3)
L_dg8:
    s_waitcnt vmcnt(9)
    buffer_load_dwordx4 v[84:87], v1, s[20:23], s28 offen offset:3072 nt
    s_add_u32 s28, s28, 0x10000
    v_mfma_f32_16x16x32_bf16 v[12:15], v[88:91], v[4:7], 0
    s_cbranch_vccnz L_dg9
    s_waitcnt vmcnt(4)
    s_cmp_eq_u32 s92, 0
    s_cbranch_scc1 L_dg9
    s_waitcnt vmcnt(3)
L_dg9:
    s_waitcnt vmcnt(9)
    buffer_load_dwordx4 v[88:91], v1, s[20:23], s28 offen offset:0 nt
    v_mfma_f32_16x16x32_bf16 v[12:15], v[92:95], v[8:11], v[12:15]
    v_add_f32_dpp v20, v16, v19 row_ror:12 row_mask:0xf bank_mask:0xf
    v_add_f32_dpp v20, v17, v20 row_ror:8 row_mask:0xf bank_mask:0xf
    v_add_f32_dpp v52, v18, v20 row_ror:4 row_mask:0xf bank_mask:0x8
    s_cbranch_vccnz L_dg10
    s_waitcnt vmcnt(4)
    s_cmp_eq_u32 s92, 0
    s_cbranch_scc1 L_dg10
    s_waitcnt vmcnt(3)
L_dg10:
    s_waitcnt vmcnt(9)
    buffer_load_dwordx4 v[92:95], v1, s[20:23], s28 offen offset:1024 nt
    v_add_u32 v22, 4, v22
    ds_write_b32 v3, v22 offset:58368
    ds_read_b32 v23, v3 offset:59392
    v_mfma_f32_16x16x32_bf16 v[16:19], v[96:99], v[4:7], 0
    s_cbranch_vccnz L_dg11
    s_waitcnt vmcnt(4)
    s_cmp_eq_u32 s92, 0
    s_cbranch_scc1 L_dg11
    s_waitcnt vmcnt(3)
L_dg11:
    s_waitcnt vmcnt(9)
    buffer_load_dwordx4 v[96:99], v1, s[20:23], s28 offen offset:2048 nt
    s_waitcnt lgkmcnt(0)
    v_cmp_gt_u32 vcc, v23, v22
    v_sub_u32 v23, v22, v23
    v_add_u32 v23, -9, v23
    v_cmp_gt_u32 s[92:93], 32, v23
    v_mfma_f32_16x16x32_bf16 v[16:19], v[100:103], v[8:11], v[16:19]
    v_add_f32_dpp v20, v13, v12 row_ror:12 row_mask:0xf bank_mask:0xf
    v_add_f32_dpp v20, v14, v20 row_ror:8 row_mask:0xf bank_mask:0xf
    v_add_f32_dpp v53, v15, v20 row_ror:4 row_mask:0xf bank_mask:0x1
    s_cbranch_vccnz L_dg12
    s_waitcnt vmcnt(4)
    s_cmp_eq_u32 s92, 0
    s_cbranch_scc1 L_dg12
    s_waitcnt vmcnt(3)
L_dg12:
    s_waitcnt vmcnt(9)
    buffer_load_dwordx4 v[100:103], v1, s[20:23], s28 offen offset:3072 nt
    s_add_u32 s28, s28, 0x10000
    v_mfma_f32_16x16x32_bf16 v[12:15], v[104:107], v[4:7], 0
    s_cbranch_vccnz L_dg13
    s_waitcnt vmcnt(4)
    s_cmp_eq_u32 s92, 0
    s_cbranch_scc1 L_dg13
    s_waitcnt vmcnt(3)
L_dg13:
    s_waitcnt vmcnt(9)
    buffer_load_dwordx4 v[104:107], v1, s[20:23], s28 offen offset:0 nt
    v_mfma_f32_16x16x32_bf16 v[12:15], v[108:111], v[8:11], v[12:15]
    v_add_f32_dpp v20, v18, v17 row_ror:12 row_mask:0xf bank_mask:0xf
    v_add_f32_dpp v20, v19, v20 row_ror:8 row_mask:0xf bank_mask:0xf
    v_add_f32_dpp v53, v16, v20 row_ror:4 row_mask:0xf bank_mask:0x2
    s_cbranch_vccnz L_dg14
    s_waitcnt vmcnt(4)
    s_cmp_eq_u32 s92, 0
    s_cbranch_scc1 L_dg14
    s_waitcnt vmcnt(3)
L_dg14:
    s_waitcnt vmcnt(9)
    buffer_load_dwordx4 v[108:111], v1, s[20:23], s28 offen offset:1024 nt
    v_add_u32 v22, 4, v22
    ds_write_b32 v3, v22 offset:58368
    ds_read_b32 v23, v3 offset:59392
    v_mfma_f32_16x16x32_bf16 v[16:19], v[112:115], v[4:7], 0
    s_cbranch_vccnz L_dg15
    s_waitcnt vmcnt(4)
    s_cmp_eq_u32 s92, 0
    s_cbranch_scc1 L_dg15
    s_waitcnt vmcnt(3)
L_dg15:
    s_waitcnt vmcnt(9)
    buffer_load_dwordx4 v[112:115], v1, s[20:23], s28 offen offset:2048 nt
    s_waitcnt lgkmcnt(0)
    v_cmp_gt_u32 vcc, v23, v22
    v_sub_u32 v23, v22, v23
    v_add_u32 v23, -9, v23
    v_cmp_gt_u32 s[92:93], 32, v23
    v_mfma_f32_16x16x32_bf16 v[16:19], v[116:119], v[8:11], v[16:19]
    v_add_f32_dpp v20, v15, v14 row_ror:12 row_mask:0xf bank_mask:0xf
    v_add_f32_dpp v20, v12, v20 row_ror:8 row_mask:0xf bank_mask:0xf
    v_add_f32_dpp v53, v13, v20 row_ror:4 row_mask:0xf bank_mask:0x4
    s_cbranch_vccnz L_dg16
    s_waitcnt vmcnt(4)
    s_cmp_eq_u32 s92, 0
    s_cbranch_scc1 L_dg16
    s_waitcnt vmcnt(3)
L_dg16:
    s_waitcnt vmcnt(9)
    buffer_load_dwordx4 v[116:119], v1, s[20:23], s28 offen offset:3072 nt
    s_add_u32 s28, s28, 0x10000
    v_mfma_f32_16x16x32_bf16 v[12:15], v[120:123], v[4:7], 0
    s_cbranch_vccnz L_dg17
    s_waitcnt vmcnt(4)
    s_cmp_eq_u32 s92, 0
    s_cbranch_scc1 L_dg17
    s_waitcnt vmcnt(3)
L_dg17:
    s_waitcnt vmcnt(9)
    buffer_load_dwordx4 v[120:123], v1, s[20:23], s28 offen offset:0 nt
    v_mfma_f32_16x16x32_bf16 v[12:15], v[124:127], v[8:11], v[12:15]
    v_add_f32_dpp v20, v16, v19 row_ror:12 row_mask:0xf bank_mask:0xf
    v_add_f32_dpp v20, v17, v20 row_ror:8 row_mask:0xf bank_mask:0xf
    v_add_f32_dpp v53, v18, v20 row_ror:4 row_mask:0xf bank_mask:0x8
    s_cbranch_vccnz L_dg18
    s_waitcnt vmcnt(4)
    s_cmp_eq_u32 s92, 0
    s_cbranch_scc1 L_dg18
    s_waitcnt vmcnt(3)
L_dg18:
    s_waitcnt vmcnt(9)
    buffer_load_dwordx4 v[124:127], v1, s[20:23], s28 offen offset:1024 nt
    v_add_u32 v22, 4, v22
    ds_write_b32 v3, v22 offset:58368
    ds_read_b32 v23, v3 offset:59392
    v_mfma_f32_16x16x32_bf16 v[16:19], v[128:131], v[4:7], 0
    s_cbranch_vccnz L_dg19
    s_waitcnt vmcnt(4)
    s_cmp_eq_u32 s92, 0
    s_cbranch_scc1 L_dg19
    s_waitcnt vmcnt(3)
L_dg19:
    s_waitcnt vmcnt(9)
    buffer_load_dwordx4 v[128:131], v1, s[20:23], s28 offen offset:2048 nt
    s_waitcnt lgkmcnt(0)
    v_cmp_gt_u32 vcc, v23, v22
    v_sub_u32 v23, v22, v23
    v_add_u32 v23, -9, v23
    v_cmp_gt_u32 s[92:93], 32, v23
    v_mfma_f32_16x16x32_bf16 v[16:19], v[132:135], v[8:11], v[16:19]
    v_add_f32_dpp v20, v13, v12 row_ror:12 row_mask:0xf bank_mask:0xf
    v_add_f32_dpp v20, v14, v20 row_ror:8 row_mask:0xf bank_mask:0xf
    v_add_f32_dpp v54, v15, v20 row_ror:4 row_mask:0xf bank_mask:0x1
    s_cbranch_vccnz L_dg20
    s_waitcnt vmcnt(4)
    s_cmp_eq_u32 s92, 0
    s_cbranch_scc1 L_dg20
    s_waitcnt vmcnt(3)
L_dg20:
    s_waitcnt vmcnt(9)
    buffer_load_dwordx4 v[132:135], v1, s[20:23], s28 offen offset:3072 nt
    s_add_u32 s28, s28, 0x10000
    v_mfma_f32_16x16x32_bf16 v[12:15], v[136:139], v[4:7], 0
    s_cbranch_vccnz L_dg21
    s_waitcnt vmcnt(4)
    s_cmp_eq_u32 s92, 0
    s_cbranch_scc1 L_dg21
    s_waitcnt vmcnt(3)
L_dg21:
    s_waitcnt vmcnt(9)
    buffer_load_dwordx4 v[136:139], v1, s[20:23], s28 offen offset:0 nt
    v_mfma_f32_16x16x32_bf16 v[12:15], v[140:143], v[8:11], v[12:15]
    v_add_f32_dpp v20, v18, v17 row_ror:12 row_mask:0xf bank_mask:0xf
    v_add_f32_dpp v20, v19, v20 row_ror:8 row_mask:0xf bank_mask:0xf
    v_add_f32_dpp v54, v16, v20 row_ror:4 row_mask:0xf bank_mask:0x2
    s_cbranch_vccnz L_dg22
    s_waitcnt vmcnt(4)
    s_cmp_eq_u32 s92, 0
    s_cbranch_scc1 L_dg22
    s_waitcnt vmcnt(3)
L_dg22:
    s_waitcnt vmcnt(9)
    buffer_load_dwordx4 v[140:143], v1, s[20:23], s28 offen offset:1024 nt
    v_add_u32 v22, 4, v22
    ds_write_b32 v3, v22 offset:58368
    ds_read_b32 v23, v3 offset:59392
    v_mfma_f32_16x16x32_bf16 v[16:19], v[144:147], v[4:7], 0
    s_cbranch_vccnz L_dg23
    s_waitcnt vmcnt(4)
    s_cmp_eq_u32 s92, 0
    s_cbranch_scc1 L_dg23
    s_waitcnt vmcnt(3)
L_dg23:
    s_waitcnt vmcnt(9)
    buffer_load_dwordx4 v[144:147], v1, s[20:23], s28 offen offset:2048 nt
    s_waitcnt lgkmcnt(0)
    v_cmp_gt_u32 vcc, v23, v22
    v_sub_u32 v23, v22, v23
    v_add_u32 v23, -9, v23
    v_cmp_gt_u32 s[92:93], 32, v23
    v_mfma_f32_16x16x32_bf16 v[16:19], v[148:151], v[8:11], v[16:19]
    v_add_f32_dpp v20, v15, v14 row_ror:12 row_mask:0xf bank_mask:0xf
    v_add_f32_dpp v20, v12, v20 row_ror:8 row_mask:0xf bank_mask:0xf
    v_add_f32_dpp v54, v13, v20 row_ror:4 row_mask:0xf bank_mask:0x4
    s_cbranch_vccnz L_dg24
    s_waitcnt vmcnt(4)
    s_cmp_eq_u32 s92, 0
    s_cbranch_scc1 L_dg24
    s_waitcnt vmcnt(3)
L_dg24:
    s_waitcnt vmcnt(9)
    buffer_load_dwordx4 v[148:151], v1, s[20:23], s28 offen offset:3072 nt
    s_add_u32 s28, s28, 0x10000
    v_mfma_f32_16x16x32_bf16 v[12:15], v[152:155], v[4:7], 0
    s_cbranch_vccnz L_dg25
    s_waitcnt vmcnt(4)
    s_cmp_eq_u32 s92, 0
    s_cbranch_scc1 L_dg25
    s_waitcnt vmcnt(3)
L_dg25:
    s_waitcnt vmcnt(9)
    buffer_load_dwordx4 v[152:155], v1, s[20:23], s28 offen offset:0 nt
    v_mfma_f32_16x16x32_bf16 v[12:15], v[156:159], v[8:11], v[12:15]
    v_add_f32_dpp v20, v16, v19 row_ror:12 row_mask:0xf bank_mask:0xf
    v_add_f32_dpp v20, v17, v20 row_ror:8 row_mask:0xf bank_mask:0xf
    v_add_f32_dpp v54, v18, v20 row_ror:4 row_mask:0xf bank_mask:0x8
    s_cbranch_vccnz L_dg26
    s_waitcnt vmcnt(4)
    s_cmp_eq_u32 s92, 0
    s_cbranch_scc1 L_dg26
    s_waitcnt vmcnt(3)
L_dg26:
    s_waitcnt vmcnt(9)
    buffer_load_dwordx4 v[156:159], v1, s[20:23], s28 offen offset:1024 nt
    v_add_u32 v22, 4, v22
    ds_write_b32 v3, v22 offset:58368
    ds_read_b32 v23, v3 offset:59392
    v_mfma_f32_16x16x32_bf16 v[16:19], v[160:163], v[4:7], 0
    s_cbranch_vccnz L_dg27
    s_waitcnt vmcnt(4)
    s_cmp_eq_u32 s92, 0
    s_cbranch_scc1 L_dg27
    s_waitcnt vmcnt(3)
L_dg27:
    s_waitcnt vmcnt(9)
    buffer_load_dwordx4 v[160:163], v1, s[20:23], s28 offen offset:2048 nt
    s_waitcnt lgkmcnt(0)
    v_cmp_gt_u32 vcc, v23, v22
    v_sub_u32 v23, v22, v23
    v_add_u32 v23, -9, v23
    v_cmp_gt_u32 s[92:93], 32, v23
    v_mfma_f32_16x16x32_bf16 v[16:19], v[164:167], v[8:11], v[16:19]
    v_add_f32_dpp v20, v13, v12 row_ror:12 row_mask:0xf bank_mask:0xf
    v_add_f32_dpp v20, v14, v20 row_ror:8 row_mask:0xf bank_mask:0xf
    v_add_f32_dpp v55, v15, v20 row_ror:4 row_mask:0xf bank_mask:0x1
    s_cbranch_vccnz L_dg28
    s_waitcnt vmcnt(4)
    s_cmp_eq_u32 s92, 0
    s_cbranch_scc1 L_dg28
    s_waitcnt vmcnt(3)
L_dg28:
    s_waitcnt vmcnt(9)
    buffer_load_dwordx4 v[164:167], v1, s[20:23], s28 offen offset:3072 nt
    s_add_u32 s28, s28, 0x10000
    v_mfma_f32_16x16x32_bf16 v[12:15], v[168:171], v[4:7], 0
    s_cbranch_vccnz L_dg29
    s_waitcnt vmcnt(4)
    s_cmp_eq_u32 s92, 0
    s_cbranch_scc1 L_dg29
    s_waitcnt vmcnt(3)
L_dg29:
    s_waitcnt vmcnt(9)
    buffer_load_dwordx4 v[168:171], v1, s[20:23], s28 offen offset:0 nt
    v_mfma_f32_16x16x32_bf16 v[12:15], v[172:175], v[8:11], v[12:15]
    v_add_f32_dpp v20, v18, v17 row_ror:12 row_mask:0xf bank_mask:0xf
    v_add_f32_dpp v20, v19, v20 row_ror:8 row_mask:0xf bank_mask:0xf
    v_add_f32_dpp v55, v16, v20 row_ror:4 row_mask:0xf bank_mask:0x2
    s_cbranch_vccnz L_dg30
    s_waitcnt vmcnt(4)
    s_cmp_eq_u32 s92, 0
    s_cbranch_scc1 L_dg30
    s_waitcnt vmcnt(3)
L_dg30:
    s_waitcnt vmcnt(9)
    buffer_load_dwordx4 v[172:175], v1, s[20:23], s28 offen offset:1024 nt
    v_add_u32 v22, 4, v22
    ds_write_b32 v3, v22 offset:58368
    ds_read_b32 v23, v3 offset:59392
    v_mfma_f32_16x16x32_bf16 v[16:19], v[176:179], v[4:7], 0
    s_cbranch_vccnz L_dg31
    s_waitcnt vmcnt(4)
    s_cmp_eq_u32 s92, 0
    s_cbranch_scc1 L_dg31
    s_waitcnt vmcnt(3)
L_dg31:
    s_waitcnt vmcnt(9)
    buffer_load_dwordx4 v[176:179], v1, s[20:23], s28 offen offset:2048 nt
    s_waitcnt lgkmcnt(0)
    v_cmp_gt_u32 vcc, v23, v22
    v_sub_u32 v23, v22, v23
    v_add_u32 v23, -9, v23
    v_cmp_gt_u32 s[92:93], 32, v23
    v_mfma_f32_16x16x32_bf16 v[16:19], v[180:183], v[8:11], v[16:19]
    v_add_f32_dpp v20, v15, v14 row_ror:12 row_mask:0xf bank_mask:0xf
    v_add_f32_dpp v20, v12, v20 row_ror:8 row_mask:0xf bank_mask:0xf
    v_add_f32_dpp v55, v13, v20 row_ror:4 row_mask:0xf bank_mask:0x4
    s_cbranch_vccnz L_dg32
    s_waitcnt vmcnt(4)
    s_cmp_eq_u32 s92, 0
    s_cbranch_scc1 L_dg32
    s_waitcnt vmcnt(3)
L_dg32:
    s_waitcnt vmcnt(9)
    buffer_load_dwordx4 v[180:183], v1, s[20:23], s28 offen offset:3072 nt
    s_add_u32 s28, s28, 0x10000
    s_add_u32 s29, s29, 1
    s_cmp_lt_u32 s29, 3
    s_cbranch_scc1 L_kloop
    v_mfma_f32_16x16x32_bf16 v[12:15], v[56:59], v[4:7], 0
    v_mfma_f32_16x16x32_bf16 v[12:15], v[60:63], v[8:11], v[12:15]
    s_nop 0
    v_add_f32_dpp v20, v16, v19 row_ror:12 row_mask:0xf bank_mask:0xf
    v_add_f32_dpp v20, v17, v20 row_ror:8 row_mask:0xf bank_mask:0xf
    v_add_f32_dpp v55, v18, v20 row_ror:4 row_mask:0xf bank_mask:0x8
    v_mov_b32 v40, v44
    v_mov_b32 v41, v45
    v_mov_b32 v42, v46
    v_mov_b32 v43, v47
    v_mov_b32 v44, v48
    v_mov_b32 v45, v49
    v_mov_b32 v46, v50
    v_mov_b32 v47, v51
    v_mov_b32 v48, v52
    v_mov_b32 v49, v53
    v_mov_b32 v50, v54
    v_mov_b32 v51, v55
    s_cbranch_vccnz L_dg33
    s_waitcnt vmcnt(4)
    s_cmp_eq_u32 s92, 0
    s_cbranch_scc1 L_dg33
    s_waitcnt vmcnt(3)
L_dg33:
    s_waitcnt vmcnt(9)
    buffer_load_dwordx4 v[56:59], v2, s[24:27], s33 offen offset:0 nt
    v_mfma_f32_16x16x32_bf16 v[16:19], v[64:67], v[4:7], 0
    v_mfma_f32_16x16x32_bf16 v[16:19], v[68:71], v[8:11], v[16:19]
    s_nop 0
    v_add_f32_dpp v20, v13, v12 row_ror:12 row_mask:0xf bank_mask:0xf
    v_add_f32_dpp v20, v14, v20 row_ror:8 row_mask:0xf bank_mask:0xf
    v_add_f32_dpp v52, v15, v20 row_ror:4 row_mask:0xf bank_mask:0x1
    s_nop 1
    v_mfma_f32_16x16x32_bf16 v[12:15], v[72:75], v[4:7], 0
    v_mfma_f32_16x16x32_bf16 v[12:15], v[76:79], v[8:11], v[12:15]
    s_nop 0
    v_add_f32_dpp v20, v18, v17 row_ror:12 row_mask:0xf bank_mask:0xf
    v_add_f32_dpp v20, v19, v20 row_ror:8 row_mask:0xf bank_mask:0xf
    v_add_f32_dpp v52, v16, v20 row_ror:4 row_mask:0xf bank_mask:0x2
    s_nop 1
    v_mfma_f32_16x16x32_bf16 v[16:19], v[80:83], v[4:7], 0
    v_mfma_f32_16x16x32_bf16 v[16:19], v[84:87], v[8:11], v[16:19]
    s_nop 0
    v_add_f32_dpp v20, v15, v14 row_ror:12 row_mask:0xf bank_mask:0xf
    v_add_f32_dpp v20, v12, v20 row_ror:8 row_mask:0xf bank_mask:0xf
    v_add_f32_dpp v52, v13, v20 row_ror:4 row_mask:0xf bank_mask:0x4
    s_cbranch_vccnz L_dg34
    s_waitcnt vmcnt(4)
    s_cmp_eq_u32 s92, 0
    s_cbranch_scc1 L_dg34
    s_waitcnt vmcnt(3)
L_dg34:
    s_waitcnt vmcnt(9)
    buffer_load_dwordx4 v[60:63], v2, s[24:27], s33 offen offset:1024 nt
    v_mfma_f32_16x16x32_bf16 v[12:15], v[88:91], v[4:7], 0
    v_mfma_f32_16x16x32_bf16 v[12:15], v[92:95], v[8:11], v[12:15]
    s_nop 0
    v_add_f32_dpp v20, v16, v19 row_ror:12 row_mask:0xf bank_mask:0xf
    v_add_f32_dpp v20, v17, v20 row_ror:8 row_mask:0xf bank_mask:0xf
    v_add_f32_dpp v52, v18, v20 row_ror:4 row_mask:0xf bank_mask:0x8
    s_nop 1
    v_mfma_f32_16x16x32_bf16 v[16:19], v[96:99], v[4:7], 0
    v_mfma_f32_16x16x32_bf16 v[16:19], v[100:103], v[8:11], v[16:19]
    s_nop 0
    v_add_f32_dpp v20, v13, v12 row_ror:12 row_mask:0xf bank_mask:0xf
    v_add_f32_dpp v20, v14, v20 row_ror:8 row_mask:0xf bank_mask:0xf
    v_add_f32_dpp v53, v15, v20 row_ror:4 row_mask:0xf bank_mask:0x1
    s_nop 1
    v_mfma_f32_16x16x32_bf16 v[12:15], v[104:107], v[4:7], 0
    v_mfma_f32_16x16x32_bf16 v[12:15], v[108:111], v[8:11], v[12:15]
    s_nop 0
    v_add_f32_dpp v20, v18, v17 row_ror:12 row_mask:0xf bank_mask:0xf
    v_add_f32_dpp v20, v19, v20 row_ror:8 row_mask:0xf bank_mask:0xf
    v_add_f32_dpp v53, v16, v20 row_ror:4 row_mask:0xf bank_mask:0x2
    v_add_u32 v22, 4, v22
    ds_write_b32 v3, v22 offset:58368
    ds_read_b32 v23, v3 offset:59392
    s_cbranch_vccnz L_dg35
    s_waitcnt vmcnt(4)
    s_cmp_eq_u32 s92, 0
    s_cbranch_scc1 L_dg35
    s_waitcnt vmcnt(3)
L_dg35:
    s_waitcnt vmcnt(9)
    buffer_load_dwordx4 v[64:67], v2, s[24:27], s33 offen offset:2048 nt
    v_mfma_f32_16x16x32_bf16 v[16:19], v[112:115], v[4:7], 0
    v_mfma_f32_16x16x32_bf16 v[16:19], v[116:119], v[8:11], v[16:19]
    s_nop 0
    v_add_f32_dpp v20, v15, v14 row_ror:12 row_mask:0xf bank_mask:0xf
    v_add_f32_dpp v20, v12, v20 row_ror:8 row_mask:0xf bank_mask:0xf
    v_add_f32_dpp v53, v13, v20 row_ror:4 row_mask:0xf bank_mask:0x4
    s_nop 1
    v_mfma_f32_16x16x32_bf16 v[12:15], v[120:123], v[4:7], 0
    v_mfma_f32_16x16x32_bf16 v[12:15], v[124:127], v[8:11], v[12:15]
    s_nop 0
    v_add_f32_dpp v20, v16, v19 row_ror:12 row_mask:0xf bank_mask:0xf
    v_add_f32_dpp v20, v17, v20 row_ror:8 row_mask:0xf bank_mask:0xf
    v_add_f32_dpp v53, v18, v20 row_ror:4 row_mask:0xf bank_mask:0x8
    s_nop 1
    v_mfma_f32_16x16x32_bf16 v[16:19], v[128:131], v[4:7], 0
    v_mfma_f32_16x16x32_bf16 v[16:19], v[132:135], v[8:11], v[16:19]
    s_nop 0
    v_add_f32_dpp v20, v13, v12 row_ror:12 row_mask:0xf bank_mask:0xf
    v_add_f32_dpp v20, v14, v20 row_ror:8 row_mask:0xf bank_mask:0xf
    v_add_f32_dpp v54, v15, v20 row_ror:4 row_mask:0xf bank_mask:0x1
    s_waitcnt lgkmcnt(0)
    v_cmp_gt_u32 vcc, v23, v22
    v_sub_u32 v23, v22, v23
    v_add_u32 v23, -9, v23
    v_cmp_gt_u32 s[92:93], 32, v23
    s_cbranch_vccnz L_dg36
    s_waitcnt vmcnt(4)
    s_cmp_eq_u32 s92, 0
    s_cbranch_scc1 L_dg36
    s_waitcnt vmcnt(3)
L_dg36:
    s_waitcnt vmcnt(9)
    buffer_load_dwordx4 v[68:71], v2, s[24:27], s33 offen offset:3072 nt
    s_add_u32 s33, s33, 0x10000
    v_mfma_f32_16x16x32_bf16 v[12:15], v[136:139], v[4:7], 0
    v_mfma_f32_16x16x32_bf16 v[12:15], v[140:143], v[8:11], v[12:15]
    s_nop 0
    v_add_f32_dpp v20, v18, v17 row_ror:12 row_mask:0xf bank_mask:0xf
    v_add_f32_dpp v20, v19, v20 row_ror:8 row_mask:0xf bank_mask:0xf
    v_add_f32_dpp v54, v16, v20 row_ror:4 row_mask:0xf bank_mask:0x2
    s_nop 1
    v_mfma_f32_16x16x32_bf16 v[16:19], v[144:147], v[4:7], 0
    v_mfma_f32_16x16x32_bf16 v[16:19], v[148:151], v[8:11], v[16:19]
    s_nop 0
    v_add_f32_dpp v20, v15, v14 row_ror:12 row_mask:0xf bank_mask:0xf
    v_add_f32_dpp v20, v12, v20 row_ror:8 row_mask:0xf bank_mask:0xf
    v_add_f32_dpp v54, v13, v20 row_ror:4 row_mask:0xf bank_mask:0x4
    s_nop 1
    v_mfma_f32_16x16x32_bf16 v[12:15], v[152:155], v[4:7], 0
    v_mfma_f32_16x16x32_bf16 v[12:15], v[156:159], v[8:11], v[12:15]
    s_nop 0
    v_add_f32_dpp v20, v16, v19 row_ror:12 row_mask:0xf bank_mask:0xf
    v_add_f32_dpp v20, v17, v20 row_ror:8 row_mask:0xf bank_mask:0xf
    v_add_f32_dpp v54, v18, v20 row_ror:4 row_mask:0xf bank_mask:0x8
    s_cbranch_vccnz L_dg37
    s_waitcnt vmcnt(4)
    s_cmp_eq_u32 s92, 0
    s_cbranch_scc1 L_dg37
    s_waitcnt vmcnt(3)
L_dg37:
    s_waitcnt vmcnt(9)
    buffer_load_dwordx4 v[72:75], v2, s[24:27], s33 offen offset:0 nt
    s_waitcnt vmcnt(9)
    v_mfma_f32_16x16x32_bf16 v[16:19], v[160:163], v[4:7], 0
    v_mfma_f32_16x16x32_bf16 v[16:19], v[164:167], v[8:11], v[16:19]
    s_nop 0
    v_add_f32_dpp v20, v13, v12 row_ror:12 row_mask:0xf bank_mask:0xf
    v_add_f32_dpp v20, v14, v20 row_ror:8 row_mask:0xf bank_mask:0xf
    v_add_f32_dpp v55, v15, v20 row_ror:4 row_mask:0xf bank_mask:0x1
    s_nop 1
    s_waitcnt vmcnt(7)
    v_mfma_f32_16x16x32_bf16 v[12:15], v[168:171], v[4:7], 0
    v_mfma_f32_16x16x32_bf16 v[12:15], v[172:175], v[8:11], v[12:15]
    s_nop 0
    v_add_f32_dpp v20, v18, v17 row_ror:12 row_mask:0xf bank_mask:0xf
    v_add_f32_dpp v20, v19, v20 row_ror:8 row_mask:0xf bank_mask:0xf
    v_add_f32_dpp v55, v16, v20 row_ror:4 row_mask:0xf bank_mask:0x2
    s_nop 1
    s_waitcnt vmcnt(5)
    v_mfma_f32_16x16x32_bf16 v[16:19], v[176:179], v[4:7], 0
    v_mfma_f32_16x16x32_bf16 v[16:19], v[180:183], v[8:11], v[16:19]
    s_nop 0
    v_add_f32_dpp v20, v15, v14 row_ror:12 row_mask:0xf bank_mask:0xf
    v_add_f32_dpp v20, v12, v20 row_ror:8 row_mask:0xf bank_mask:0xf
    v_add_f32_dpp v55, v13, v20 row_ror:4 row_mask:0xf bank_mask:0x4
    s_cbranch_vccnz L_dg38
    s_waitcnt vmcnt(4)
    s_cmp_eq_u32 s92, 0
    s_cbranch_scc1 L_dg38
    s_waitcnt vmcnt(3)
L_dg38:
    s_waitcnt vmcnt(9)
    buffer_load_dwordx4 v[76:79], v2, s[24:27], s33 offen offset:1024 nt
    s_nop 1
    v_add_f32_dpp v20, v16, v19 row_ror:12 row_mask:0xf bank_mask:0xf
    v_add_f32_dpp v20, v17, v20 row_ror:8 row_mask:0xf bank_mask:0xf
    v_add_f32_dpp v55, v18, v20 row_ror:4 row_mask:0xf bank_mask:0x8
    v_max3_f32 v36, v40, v41, v42
    v_max3_f32 v20, v43, v44, v45
    v_max3_f32 v36, v36, v46, v47
    v_max3_f32 v20, v20, v48, v49
    v_max3_f32 v36, v36, v50, v51
    v_max3_f32 v20, v20, v52, v53
    v_max3_f32 v36, v36, v54, v55
    v_max_f32 v36, v36, v20
    s_nop 1
    v_max_f32_dpp v36, v36, v36 row_ror:2 row_mask:0xf bank_mask:0xf
    s_nop 1
    v_max_f32_dpp v36, v36, v36 row_ror:4 row_mask:0xf bank_mask:0xf
    s_nop 1
    v_max_f32_dpp v36, v36, v36 row_ror:8 row_mask:0xf bank_mask:0xf
    v_mov_b32 v20, v36
    s_nop 1
    v_permlane16_swap_b32 v36, v20
    v_max_f32 v36, v36, v20
    v_mov_b32 v20, v36
    s_nop 1
    v_permlane32_swap_b32 v36, v20
    v_max_f32 v36, v36, v20
    v_mul_f32 v36, s30, v36
    v_add_u32 v22, 4, v22
    ds_write_b32 v3, v22 offset:58368
    ds_read_b32 v23, v3 offset:59392
    s_cbranch_vccnz L_dg39
    s_waitcnt vmcnt(4)
    s_cmp_eq_u32 s92, 0
    s_cbranch_scc1 L_dg39
    s_waitcnt vmcnt(3)
L_dg39:
    s_waitcnt vmcnt(9)
    buffer_load_dwordx4 v[80:83], v2, s[24:27], s33 offen offset:2048 nt
    v_fma_f32 v40, v40, s30, -v36
    v_exp_f32 v40, v40
    v_fma_f32 v41, v41, s30, -v36
    v_exp_f32 v41, v41
    v_fma_f32 v42, v42, s30, -v36
    v_exp_f32 v42, v42
    v_fma_f32 v43, v43, s30, -v36
    v_exp_f32 v43, v43
    v_fma_f32 v44, v44, s30, -v36
    v_exp_f32 v44, v44
    v_fma_f32 v45, v45, s30, -v36
    v_exp_f32 v45, v45
    v_fma_f32 v46, v46, s30, -v36
    v_exp_f32 v46, v46
    v_fma_f32 v47, v47, s30, -v36
    v_exp_f32 v47, v47
    v_fma_f32 v48, v48, s30, -v36
    v_exp_f32 v48, v48
    v_fma_f32 v49, v49, s30, -v36
    v_exp_f32 v49, v49
    v_fma_f32 v50, v50, s30, -v36
    v_exp_f32 v50, v50
    s_waitcnt lgkmcnt(0)
    v_cmp_gt_u32 vcc, v23, v22
    v_sub_u32 v23, v22, v23
    v_add_u32 v23, -9, v23
    v_cmp_gt_u32 s[92:93], 32, v23
    s_cbranch_vccnz L_dg40
    s_waitcnt vmcnt(4)
    s_cmp_eq_u32 s92, 0
    s_cbranch_scc1 L_dg40
    s_waitcnt vmcnt(3)
L_dg40:
    s_waitcnt vmcnt(9)
    buffer_load_dwordx4 v[84:87], v2, s[24:27], s33 offen offset:3072 nt
    s_add_u32 s33, s33, 0x10000
    v_fma_f32 v51, v51, s30, -v36
    v_exp_f32 v51, v51
    v_fma_f32 v52, v52, s30, -v36
    v_exp_f32 v52, v52
    v_fma_f32 v53, v53, s30, -v36
    v_exp_f32 v53, v53
    v_fma_f32 v54, v54, s30, -v36
    v_exp_f32 v54, v54
    v_fma_f32 v55, v55, s30, -v36
    v_exp_f32 v55, v55
    v_add_f32 v37, v40, v41
    v_add_f32 v37, v37, v42
    v_add_f32 v37, v37, v43
    v_add_f32 v37, v37, v44
    v_add_f32 v37, v37, v45
    v_add_f32 v37, v37, v46
    v_add_f32 v37, v37, v47
    v_add_f32 v37, v37, v48
    v_add_f32 v37, v37, v49
    v_add_f32 v37, v37, v50
    v_add_f32 v37, v37, v51
    v_add_f32 v37, v37, v52
    v_add_f32 v37, v37, v53
    v_add_f32 v37, v37, v54
    v_add_f32 v37, v37, v55
    s_cbranch_vccnz L_dg41
    s_waitcnt vmcnt(4)
    s_cmp_eq_u32 s92, 0
    s_cbranch_scc1 L_dg41
    s_waitcnt vmcnt(3)
L_dg41:
    s_waitcnt vmcnt(9)
    buffer_load_dwordx4 v[88:91], v2, s[24:27], s33 offen offset:0 nt
    v_mov_b32_dpp v39, v40 quad_perm:[1,0,3,2] row_mask:0xf bank_mask:0xf
    v_cvt_pk_bf16_f32 v40, v40, v39
    v_mov_b32_dpp v38, v41 quad_perm:[1,0,3,2] row_mask:0xf bank_mask:0xf
    v_cvt_pk_bf16_f32 v41, v41, v38
    v_mov_b32_dpp v39, v42 quad_perm:[1,0,3,2] row_mask:0xf bank_mask:0xf
    v_cvt_pk_bf16_f32 v42, v42, v39
    v_mov_b32_dpp v38, v43 quad_perm:[1,0,3,2] row_mask:0xf bank_mask:0xf
    v_cvt_pk_bf16_f32 v43, v43, v38
    v_mov_b32_dpp v39, v44 quad_perm:[1,0,3,2] row_mask:0xf bank_mask:0xf
    v_cvt_pk_bf16_f32 v44, v44, v39
    v_mov_b32_dpp v38, v45 quad_perm:[1,0,3,2] row_mask:0xf bank_mask:0xf
    v_cvt_pk_bf16_f32 v45, v45, v38
    v_mov_b32_dpp v39, v46 quad_perm:[1,0,3,2] row_mask:0xf bank_mask:0xf
    v_cvt_pk_bf16_f32 v46, v46, v39
    v_mov_b32_dpp v38, v47 quad_perm:[1,0,3,2] row_mask:0xf bank_mask:0xf
    v_cvt_pk_bf16_f32 v47, v47, v38
    v_mov_b32_dpp v39, v48 quad_perm:[1,0,3,2] row_mask:0xf bank_mask:0xf
    v_cvt_pk_bf16_f32 v48, v48, v39
    v_mov_b32_dpp v38, v49 quad_perm:[1,0,3,2] row_mask:0xf bank_mask:0xf
    v_cvt_pk_bf16_f32 v49, v49, v38
    v_mov_b32_dpp v39, v50 quad_perm:[1,0,3,2] row_mask:0xf bank_mask:0xf
    v_cvt_pk_bf16_f32 v50, v50, v39
    v_mov_b32_dpp v38, v51 quad_perm:[1,0,3,2] row_mask:0xf bank_mask:0xf
    v_cvt_pk_bf16_f32 v51, v51, v38
    v_mov_b32_dpp v39, v52 quad_perm:[1,0,3,2] row_mask:0xf bank_mask:0xf
    v_cvt_pk_bf16_f32 v52, v52, v39
    v_mov_b32_dpp v38, v53 quad_perm:[1,0,3,2] row_mask:0xf bank_mask:0xf
    v_cvt_pk_bf16_f32 v53, v53, v38
    v_mov_b32_dpp v39, v54 quad_perm:[1,0,3,2] row_mask:0xf bank_mask:0xf
    v_cvt_pk_bf16_f32 v54, v54, v39
    v_mov_b32_dpp v38, v55 quad_perm:[1,0,3,2] row_mask:0xf bank_mask:0xf
    v_cvt_pk_bf16_f32 v55, v55, v38
    s_cbranch_vccnz L_dg42
    s_waitcnt vmcnt(4)
    s_cmp_eq_u32 s92, 0
    s_cbranch_scc1 L_dg42
    s_waitcnt vmcnt(3)
L_dg42:
    s_waitcnt vmcnt(9)
    buffer_load_dwordx4 v[92:95], v2, s[24:27], s33 offen offset:1024 nt
    s_nop 1
    v_add_f32_dpp v37, v37, v37 row_ror:2 row_mask:0xf bank_mask:0xf
    s_nop 1
    v_add_f32_dpp v37, v37, v37 row_ror:4 row_mask:0xf bank_mask:0xf
    s_nop 1
    v_add_f32_dpp v37, v37, v37 row_ror:8 row_mask:0xf bank_mask:0xf
    v_mov_b32 v20, v37
    s_nop 1
    v_permlane16_swap_b32 v37, v20
    v_add_f32 v37, v37, v20
    v_mov_b32 v20, v37
    s_nop 1
    v_permlane32_swap_b32 v37, v20
    v_add_f32 v37, v37, v20
    v_lshlrev_b32 v38, 3, v0
    s_lshl_b32 s31, s3, 4
    v_add_u32 v38, s31, v38
    s_mov_b64 exec, 3
    ds_write_b64 v38, v[36:37] offset:53760
    s_mov_b64 exec, -1
    v_mov_b32_dpp v21, v40 row_newbcast:0 row_mask:0xf bank_mask:0x3
    v_mov_b32_dpp v21, v40 row_newbcast:1 row_mask:0xf bank_mask:0xc
    v_and_b32 v24, v21, v28
    v_and_b32 v25, v21, v29
    v_and_b32 v26, v21, v30
    v_and_b32 v27, v21, v31
    v_add_u32 v22, 4, v22
    ds_write_b32 v3, v22 offset:58368
    ds_read_b32 v23, v3 offset:59392
    s_cbranch_vccnz L_dg43
    s_waitcnt vmcnt(4)
    s_cmp_eq_u32 s92, 0
    s_cbranch_scc1 L_dg43
    s_waitcnt vmcnt(3)
L_dg43:
    s_waitcnt vmcnt(9)
    buffer_load_dwordx4 v[96:99], v2, s[24:27], s33 offen offset:2048 nt
    v_mfma_f32_16x16x32_bf16 v[32:35], v[24:27], v[184:187], 0
    v_mov_b32_dpp v21, v40 row_newbcast:2 row_mask:0xf bank_mask:0x3
    v_mov_b32_dpp v21, v40 row_newbcast:3 row_mask:0xf bank_mask:0xc
    v_and_b32 v24, v21, v28
    v_and_b32 v25, v21, v29
    v_and_b32 v26, v21, v30
    v_and_b32 v27, v21, v31
    s_nop 1
    v_mfma_f32_16x16x32_bf16 v[32:35], v[24:27], v[188:191], v[32:35]
    v_mov_b32_dpp v21, v40 row_newbcast:4 row_mask:0xf bank_mask:0x3
    v_mov_b32_dpp v21, v40 row_newbcast:5 row_mask:0xf bank_mask:0xc
    v_and_b32 v24, v21, v28
    v_and_b32 v25, v21, v29
    v_and_b32 v26, v21, v30
    v_and_b32 v27, v21, v31
    s_nop 1
    v_mfma_f32_16x16x32_bf16 v[32:35], v[24:27], v[192:195], v[32:35]
    v_mov_b32_dpp v21, v40 row_newbcast:6 row_mask:0xf bank_mask:0x3
    v_mov_b32_dpp v21, v40 row_newbcast:7 row_mask:0xf bank_mask:0xc
    v_and_b32 v24, v21, v28
    v_and_b32 v25, v21, v29
    v_and_b32 v26, v21, v30
    v_and_b32 v27, v21, v31
    s_waitcnt lgkmcnt(0)
    v_cmp_gt_u32 vcc, v23, v22
    v_sub_u32 v23, v22, v23
    v_add_u32 v23, -9, v23
    v_cmp_gt_u32 s[92:93], 32, v23
    s_cbranch_vccnz L_dg44
    s_waitcnt vmcnt(4)
    s_cmp_eq_u32 s92, 0
    s_cbranch_scc1 L_dg44
    s_waitcnt vmcnt(3)
L_dg44:
    s_waitcnt vmcnt(9)
    buffer_load_dwordx4 v[100:103], v2, s[24:27], s33 offen offset:3072 nt
    s_add_u32 s33, s33, 0x10000
    v_mfma_f32_16x16x32_bf16 v[32:35], v[24:27], v[196:199], v[32:35]
    v_mov_b32_dpp v21, v40 row_newbcast:8 row_mask:0xf bank_mask:0x3
    v_mov_b32_dpp v21, v40 row_newbcast:9 row_mask:0xf bank_mask:0xc
    v_and_b32 v24, v21, v28
    v_and_b32 v25, v21, v29
    v_and_b32 v26, v21, v30
    v_and_b32 v27, v21, v31
    s_nop 1
    v_mfma_f32_16x16x32_bf16 v[32:35], v[24:27], v[200:203], v[32:35]
    v_mov_b32_dpp v21, v40 row_newbcast:10 row_mask:0xf bank_mask:0x3
    v_mov_b32_dpp v21, v40 row_newbcast:11 row_mask:0xf bank_mask:0xc
    v_and_b32 v24, v21, v28
    v_and_b32 v25, v21, v29
    v_and_b32 v26, v21, v30
    v_and_b32 v27, v21, v31
    s_nop 1
    v_mfma_f32_16x16x32_bf16 v[32:35], v[24:27], v[204:207], v[32:35]
    v_mov_b32_dpp v21, v40 row_newbcast:12 row_mask:0xf bank_mask:0x3
    v_mov_b32_dpp v21, v40 row_newbcast:13 row_mask:0xf bank_mask:0xc
    v_and_b32 v24, v21, v28
    v_and_b32 v25, v21, v29
    v_and_b32 v26, v21, v30
    v_and_b32 v27, v21, v31
    s_cbranch_vccnz L_dg45
    s_waitcnt vmcnt(4)
    s_cmp_eq_u32 s92, 0
    s_cbranch_scc1 L_dg45
    s_waitcnt vmcnt(3)
L_dg45:
    s_waitcnt vmcnt(9)
    buffer_load_dwordx4 v[104:107], v2, s[24:27], s33 offen offset:0 nt
    v_mfma_f32_16x16x32_bf16 v[32:35], v[24:27], v[208:211], v[32:35]
    v_mov_b32_dpp v21, v40 row_newbcast:14 row_mask:0xf bank_mask:0x3
    v_mov_b32_dpp v21, v40 row_newbcast:15 row_mask:0xf bank_mask:0xc
    v_and_b32 v24, v21, v28
    v_and_b32 v25, v21, v29
    v_and_b32 v26, v21, v30
    v_and_b32 v27, v21, v31
    s_nop 1
    v_mfma_f32_16x16x32_bf16 v[32:35], v[24:27], v[212:215], v[32:35]
    v_mov_b32_dpp v21, v41 row_newbcast:0 row_mask:0xf bank_mask:0x3
    v_mov_b32_dpp v21, v41 row_newbcast:1 row_mask:0xf bank_mask:0xc
    v_and_b32 v24, v21, v28
    v_and_b32 v25, v21, v29
    v_and_b32 v26, v21, v30
    v_and_b32 v27, v21, v31
    s_nop 1
    v_mfma_f32_16x16x32_bf16 v[32:35], v[24:27], v[216:219], v[32:35]
    v_mov_b32_dpp v21, v41 row_newbcast:2 row_mask:0xf bank_mask:0x3
    v_mov_b32_dpp v21, v41 row_newbcast:3 row_mask:0xf bank_mask:0xc
    v_and_b32 v24, v21, v28
    v_and_b32 v25, v21, v29
    v_and_b32 v26, v21, v30
    v_and_b32 v27, v21, v31
    s_cbranch_vccnz L_dg46
    s_waitcnt vmcnt(4)
    s_cmp_eq_u32 s92, 0
    s_cbranch_scc1 L_dg46
    s_waitcnt vmcnt(3)
L_dg46:
    s_waitcnt vmcnt(9)
    buffer_load_dwordx4 v[108:111], v2, s[24:27], s33 offen offset:1024 nt
    v_mfma_f32_16x16x32_bf16 v[32:35], v[24:27], v[220:223], v[32:35]
    v_mov_b32_dpp v21, v41 row_newbcast:4 row_mask:0xf bank_mask:0x3
    v_mov_b32_dpp v21, v41 row_newbcast:5 row_mask:0xf bank_mask:0xc
    v_and_b32 v24, v21, v28
    v_and_b32 v25, v21, v29
    v_and_b32 v26, v21, v30
    v_and_b32 v27, v21, v31
    s_nop 1
    v_mfma_f32_16x16x32_bf16 v[32:35], v[24:27], v[224:227], v[32:35]
    v_mov_b32_dpp v21, v41 row_newbcast:6 row_mask:0xf bank_mask:0x3
    v_mov_b32_dpp v21, v41 row_newbcast:7 row_mask:0xf bank_mask:0xc
    v_and_b32 v24, v21, v28
    v_and_b32 v25, v21, v29
    v_and_b32 v26, v21, v30
    v_and_b32 v27, v21, v31
    s_nop 1
    v_mfma_f32_16x16x32_bf16 v[32:35], v[24:27], v[228:231], v[32:35]
    v_mov_b32_dpp v21, v41 row_newbcast:8 row_mask:0xf bank_mask:0x3
    v_mov_b32_dpp v21, v41 row_newbcast:9 row_mask:0xf bank_mask:0xc
    v_and_b32 v24, v21, v28
    v_and_b32 v25, v21, v29
    v_and_b32 v26, v21, v30
    v_and_b32 v27, v21, v31
    v_add_u32 v22, 4, v22
    ds_write_b32 v3, v22 offset:58368
    ds_read_b32 v23, v3 offset:59392
    s_cbranch_vccnz L_dg47
    s_waitcnt vmcnt(4)
    s_cmp_eq_u32 s92, 0
    s_cbranch_scc1 L_dg47
    s_waitcnt vmcnt(3)
L_dg47:
    s_waitcnt vmcnt(9)
    buffer_load_dwordx4 v[112:115], v2, s[24:27], s33 offen offset:2048 nt
    v_mfma_f32_16x16x32_bf16 v[32:35], v[24:27], v[232:235], v[32:35]
    v_mov_b32_dpp v21, v41 row_newbcast:10 row_mask:0xf bank_mask:0x3
    v_mov_b32_dpp v21, v41 row_newbcast:11 row_mask:0xf bank_mask:0xc
    v_and_b32 v24, v21, v28
    v_and_b32 v25, v21, v29
    v_and_b32 v26, v21, v30
    v_and_b32 v27, v21, v31
    s_nop 1
    v_mfma_f32_16x16x32_bf16 v[32:35], v[24:27], v[236:239], v[32:35]
    v_mov_b32_dpp v21, v41 row_newbcast:12 row_mask:0xf bank_mask:0x3
    v_mov_b32_dpp v21, v41 row_newbcast:13 row_mask:0xf bank_mask:0xc
    v_and_b32 v24, v21, v28
    v_and_b32 v25, v21, v29
    v_and_b32 v26, v21, v30
    v_and_b32 v27, v21, v31
    s_nop 1
    v_mfma_f32_16x16x32_bf16 v[32:35], v[24:27], v[240:243], v[32:35]
    v_mov_b32_dpp v21, v41 row_newbcast:14 row_mask:0xf bank_mask:0x3
    v_mov_b32_dpp v21, v41 row_newbcast:15 row_mask:0xf bank_mask:0xc
    v_and_b32 v24, v21, v28
    v_and_b32 v25, v21, v29
    v_and_b32 v26, v21, v30
    v_and_b32 v27, v21, v31
    s_nop 1
    v_mfma_f32_16x16x32_bf16 v[32:35], v[24:27], v[244:247], v[32:35]
    s_mov_b32 s40, s18
    s_mov_b32 s41, s19
    s_mov_b32 s42, 0x10000000
    s_mov_b32 s43, 0x20000
    v_lshlrev_b32 v190, 4, v0
    s_lshl_b32 s31, s3, 10
    v_add_u32 v190, s31, v190
    s_lshl_b32 s46, s3, 13
    s_add_u32 s46, s46, 20480
    s_cmp_ge_u32 s2, 144
    s_cbranch_scc1 L_ts_red
    s_mov_b32 s94, 9216
    s_lshr_b32 s31, s2, 3
    s_and_b32 s35, s2, 7
    s_cmp_ge_u32 s31, 9
    s_cselect_b32 s95, 8, 0
    s_add_u32 s35, s35, s95
    s_cmp_ge_u32 s31, 9
    s_cselect_b32 s95, 9, 0
    s_sub_u32 s31, s31, s95
    s_mul_i32 s47, s35, 9
    s_add_u32 s47, s47, s31
    s_mov_b32 s36, s12
    s_mov_b32 s37, s13
    s_mov_b32 s38, 0x480000
    s_mov_b32 s39, 0x20000
    s_lshl_b32 s45, s35, 2
    s_add_u32 s45, s45, s3
    s_mul_i32 s45, s45, 73728
    s_lshl_b32 s31, s31, 7
    s_add_u32 s45, s45, s31
    v_lshrrev_b32 v200, 3, v0
    v_mul_u32_u24 v201, 1152, v200
    v_and_b32 v200, 2, v200
    v_and_b32 v202, 7, v0
    v_xor_b32 v202, v202, v200
    v_lshl_add_u32 v184, v202, 4, v201
    v_xor_b32 v202, 4, v202
    v_lshl_add_u32 v185, v202, 4, v201
    v_bfe_u32 v200, v0, 3, 1
    v_bfe_u32 v201, v0, 2, 1
    v_lshl_add_u32 v202, v201, 1, v200
    v_and_b32 v203, 0x30, v0
    v_lshl_add_u32 v203, v200, 7, v203
    v_add_u32 v186, v203, v202
    v_xor_b32 v187, 1, v186
    v_bfe_u32 v200, v0, 4, 1
    v_lshl_add_u32 v200, v200, 1, v201
    v_xor_b32 v200, s3, v200
    v_lshlrev_b32 v200, 5, v200
    v_and_b32 v201, 3, v0
    v_lshl_add_u32 v200, v201, 3, v200
    v_lshl_add_u32 v186, v186, 7, v200
    v_lshl_add_u32 v187, v187, 7, v200
    s_lshl_b32 s44, s3, 4
    s_add_u32 s44, s44, s35
    s_mul_i32 s44, s44, 8192
    s_add_u32 s44, s44, 1048576
    v_lshrrev_b32 v200, 5, v0
    v_lshl_add_u32 v200, s3, 2, v200
    v_mul_u32_u24 v200, 528, v200
    v_and_b32 v201, 31, v0
    v_lshl_add_u32 v191, v201, 4, v200
    v_and_b32 v200, 15, v0
    v_mul_u32_u24 v200, 528, v200
    v_and_b32 v201, 0x30, v0
    v_add_u32 v188, v200, v201
    v_and_b32 v200, 15, v0
    v_lshlrev_b32 v200, 3, v200
    v_lshl_add_u32 v189, v201, 5, v200
    s_lshl_b32 s47, s47, 11
    s_lshl_b32 s31, s3, 7
    s_add_u32 s47, s47, s31
    s_add_u32 s47, s47, 524288
    s_branch L_ts_done
L_ts_red:
    s_mov_b32 s94, 1024
    s_mov_b32 s36, s14
    s_mov_b32 s37, s15
    s_mov_b32 s38, 0x0
    s_mov_b32 s39, 0x20000
    s_mov_b32 s45, 0
    v_mov_b32 v184, 0
    v_mov_b32 v185, 0
    v_mov_b32 v186, 0
    v_mov_b32 v187, 0
    s_sub_u32 s35, s2, 144
    v_lshrrev_b32 v200, 3, v0
    v_mul_u32_u24 v200, 18432, v200
    v_and_b32 v201, 7, v0
    v_lshl_add_u32 v188, v201, 4, v200
    s_lshl_b32 s44, s35, 9
    s_lshl_b32 s31, s3, 7
    s_add_u32 s44, s44, s31
    s_add_u32 s44, s44, 524288
    s_add_u32 s47, s44, 147456
    v_lshrrev_b32 v200, 4, v0
    v_lshl_add_u32 v200, v201, 1, v200
    v_lshlrev_b32 v189, 1, v200
L_ts_done:
    s_waitcnt lgkmcnt(0)
    v_cmp_gt_u32 vcc, v23, v22
    v_sub_u32 v23, v22, v23
    v_add_u32 v23, -9, v23
    v_cmp_gt_u32 s[92:93], 32, v23
    s_cbranch_vccnz L_dg48
    s_waitcnt vmcnt(4)
    s_cmp_eq_u32 s92, 0
    s_cbranch_scc1 L_dg48
    s_waitcnt vmcnt(3)
L_dg48:
    s_waitcnt vmcnt(9)
    buffer_load_dwordx4 v[116:119], v2, s[24:27], s33 offen offset:3072 nt
    s_add_u32 s33, s33, 0x10000
    s_mov_b32 s29, 0
.p2align 3
L_vloop:
    v_mov_b32_dpp v21, v42 row_newbcast:0 row_mask:0xf bank_mask:0x3
    v_mov_b32_dpp v21, v42 row_newbcast:1 row_mask:0xf bank_mask:0xc
    v_and_b32 v24, v21, v28
    v_and_b32 v25, v21, v29
    v_and_b32 v26, v21, v30
    v_and_b32 v27, v21, v31
    s_cbranch_vccnz L_dg49
    s_waitcnt vmcnt(4)
    s_cmp_eq_u32 s92, 0
    s_cbranch_scc1 L_dg49
    s_waitcnt vmcnt(3)
L_dg49:
    s_waitcnt vmcnt(9)
    buffer_load_dwordx4 v[120:123], v2, s[24:27], s33 offen offset:0 nt
    v_mfma_f32_16x16x32_bf16 v[32:35], v[24:27], v[56:59], v[32:35]
    v_mov_b32_dpp v21, v42 row_newbcast:2 row_mask:0xf bank_mask:0x3
    v_mov_b32_dpp v21, v42 row_newbcast:3 row_mask:0xf bank_mask:0xc
    v_and_b32 v24, v21, v28
    v_and_b32 v25, v21, v29
    v_and_b32 v26, v21, v30
    v_and_b32 v27, v21, v31
    s_cbranch_vccnz L_dg50
    s_waitcnt vmcnt(4)
    s_cmp_eq_u32 s92, 0
    s_cbranch_scc1 L_dg50
    s_waitcnt vmcnt(3)
L_dg50:
    s_waitcnt vmcnt(9)
    buffer_load_dwordx4 v[124:127], v2, s[24:27], s33 offen offset:1024 nt
    v_mfma_f32_16x16x32_bf16 v[32:35], v[24:27], v[60:63], v[32:35]
    v_add_u32 v22, 4, v22
    ds_write_b32 v3, v22 offset:58368
    ds_read_b32 v23, v3 offset:59392
    v_mov_b32_dpp v21, v42 row_newbcast:4 row_mask:0xf bank_mask:0x3
    v_mov_b32_dpp v21, v42 row_newbcast:5 row_mask:0xf bank_mask:0xc
    v_and_b32 v24, v21, v28
    v_and_b32 v25, v21, v29
    v_and_b32 v26, v21, v30
    v_and_b32 v27, v21, v31
    s_cbranch_vccnz L_dg51
    s_waitcnt vmcnt(4)
    s_cmp_eq_u32 s92, 0
    s_cbranch_scc1 L_dg51
    s_waitcnt vmcnt(3)
L_dg51:
    s_waitcnt vmcnt(9)
    buffer_load_dwordx4 v[128:131], v2, s[24:27], s33 offen offset:2048 nt
    v_mfma_f32_16x16x32_bf16 v[32:35], v[24:27], v[64:67], v[32:35]
    s_waitcnt lgkmcnt(0)
    v_cmp_gt_u32 vcc, v23, v22
    v_sub_u32 v23, v22, v23
    v_add_u32 v23, -9, v23
    v_cmp_gt_u32 s[92:93], 32, v23
    v_mov_b32_dpp v21, v42 row_newbcast:6 row_mask:0xf bank_mask:0x3
    v_mov_b32_dpp v21, v42 row_newbcast:7 row_mask:0xf bank_mask:0xc
    v_and_b32 v24, v21, v28
    v_and_b32 v25, v21, v29
    v_and_b32 v26, v21, v30
    v_and_b32 v27, v21, v31
    s_cbranch_vccnz L_dg52
    s_waitcnt vmcnt(4)
    s_cmp_eq_u32 s92, 0
    s_cbranch_scc1 L_dg52
    s_waitcnt vmcnt(3)
L_dg52:
    s_waitcnt vmcnt(9)
    buffer_load_dwordx4 v[132:135], v2, s[24:27], s33 offen offset:3072 nt
    s_add_u32 s33, s33, 0x10000
    v_mfma_f32_16x16x32_bf16 v[32:35], v[24:27], v[68:71], v[32:35]
    v_mov_b32_dpp v21, v42 row_newbcast:8 row_mask:0xf bank_mask:0x3
    v_mov_b32_dpp v21, v42 row_newbcast:9 row_mask:0xf bank_mask:0xc
    v_and_b32 v24, v21, v28
    v_and_b32 v25, v21, v29
    v_and_b32 v26, v21, v30
    v_and_b32 v27, v21, v31
    s_cbranch_vccnz L_dg53
    s_waitcnt vmcnt(4)
    s_cmp_eq_u32 s92, 0
    s_cbranch_scc1 L_dg53
    s_waitcnt vmcnt(3)
L_dg53:
    s_waitcnt vmcnt(9)
    buffer_load_dwordx4 v[136:139], v2, s[24:27], s33 offen offset:0 nt
    v_mfma_f32_16x16x32_bf16 v[32:35], v[24:27], v[72:75], v[32:35]
    v_mov_b32_dpp v21, v42 row_newbcast:10 row_mask:0xf bank_mask:0x3
    v_mov_b32_dpp v21, v42 row_newbcast:11 row_mask:0xf bank_mask:0xc
    v_and_b32 v24, v21, v28
    v_and_b32 v25, v21, v29
    v_and_b32 v26, v21, v30
    v_and_b32 v27, v21, v31
    s_cbranch_vccnz L_dg54
    s_waitcnt vmcnt(4)
    s_cmp_eq_u32 s92, 0
    s_cbranch_scc1 L_dg54
    s_waitcnt vmcnt(3)
L_dg54:
    s_waitcnt vmcnt(9)
    buffer_load_dwordx4 v[140:143], v2, s[24:27], s33 offen offset:1024 nt
    v_mfma_f32_16x16x32_bf16 v[32:35], v[24:27], v[76:79], v[32:35]
    v_add_u32 v22, 4, v22
    ds_write_b32 v3, v22 offset:58368
    ds_read_b32 v23, v3 offset:59392
    v_mov_b32_dpp v21, v42 row_newbcast:12 row_mask:0xf bank_mask:0x3
    v_mov_b32_dpp v21, v42 row_newbcast:13 row_mask:0xf bank_mask:0xc
    v_and_b32 v24, v21, v28
    v_and_b32 v25, v21, v29
    v_and_b32 v26, v21, v30
    v_and_b32 v27, v21, v31
    s_cbranch_vccnz L_dg55
    s_waitcnt vmcnt(4)
    s_cmp_eq_u32 s92, 0
    s_cbranch_scc1 L_dg55
    s_waitcnt vmcnt(3)
L_dg55:
    s_waitcnt vmcnt(9)
    buffer_load_dwordx4 v[144:147], v2, s[24:27], s33 offen offset:2048 nt
    v_mfma_f32_16x16x32_bf16 v[32:35], v[24:27], v[80:83], v[32:35]
    s_waitcnt lgkmcnt(0)
    v_cmp_gt_u32 vcc, v23, v22
    v_sub_u32 v23, v22, v23
    v_add_u32 v23, -9, v23
    v_cmp_gt_u32 s[92:93], 32, v23
    v_mov_b32_dpp v21, v42 row_newbcast:14 row_mask:0xf bank_mask:0x3
    v_mov_b32_dpp v21, v42 row_newbcast:15 row_mask:0xf bank_mask:0xc
    v_and_b32 v24, v21, v28
    v_and_b32 v25, v21, v29
    v_and_b32 v26, v21, v30
    v_and_b32 v27, v21, v31
    s_cbranch_vccnz L_dg56
    s_waitcnt vmcnt(4)
    s_cmp_eq_u32 s92, 0
    s_cbranch_scc1 L_dg56
    s_waitcnt vmcnt(3)
L_dg56:
    s_waitcnt vmcnt(9)
    buffer_load_dwordx4 v[148:151], v2, s[24:27], s33 offen offset:3072 nt
    s_add_u32 s33, s33, 0x10000
    v_mfma_f32_16x16x32_bf16 v[32:35], v[24:27], v[84:87], v[32:35]
    v_mov_b32_dpp v21, v43 row_newbcast:0 row_mask:0xf bank_mask:0x3
    v_mov_b32_dpp v21, v43 row_newbcast:1 row_mask:0xf bank_mask:0xc
    v_and_b32 v24, v21, v28
    v_and_b32 v25, v21, v29
    v_and_b32 v26, v21, v30
    v_and_b32 v27, v21, v31
    s_cbranch_vccnz L_dg57
    s_waitcnt vmcnt(4)
    s_cmp_eq_u32 s92, 0
    s_cbranch_scc1 L_dg57
    s_waitcnt vmcnt(3)
L_dg57:
    s_waitcnt vmcnt(9)
    buffer_load_dwordx4 v[152:155], v2, s[24:27], s33 offen offset:0 nt
    v_mfma_f32_16x16x32_bf16 v[32:35], v[24:27], v[88:91], v[32:35]
    v_mov_b32_dpp v21, v43 row_newbcast:2 row_mask:0xf bank_mask:0x3
    v_mov_b32_dpp v21, v43 row_newbcast:3 row_mask:0xf bank_mask:0xc
    v_and_b32 v24, v21, v28
    v_and_b32 v25, v21, v29
    v_and_b32 v26, v21, v30
    v_and_b32 v27, v21, v31
    s_cbranch_vccnz L_dg58
    s_waitcnt vmcnt(4)
    s_cmp_eq_u32 s92, 0
    s_cbranch_scc1 L_dg58
    s_waitcnt vmcnt(3)
L_dg58:
    s_waitcnt vmcnt(9)
    buffer_load_dwordx4 v[156:159], v2, s[24:27], s33 offen offset:1024 nt
    v_mfma_f32_16x16x32_bf16 v[32:35], v[24:27], v[92:95], v[32:35]
    v_add_u32 v22, 4, v22
    ds_write_b32 v3, v22 offset:58368
    ds_read_b32 v23, v3 offset:59392
    v_mov_b32_dpp v21, v43 row_newbcast:4 row_mask:0xf bank_mask:0x3
    v_mov_b32_dpp v21, v43 row_newbcast:5 row_mask:0xf bank_mask:0xc
    v_and_b32 v24, v21, v28
    v_and_b32 v25, v21, v29
    v_and_b32 v26, v21, v30
    v_and_b32 v27, v21, v31
    s_cbranch_vccnz L_dg59
    s_waitcnt vmcnt(4)
    s_cmp_eq_u32 s92, 0
    s_cbranch_scc1 L_dg59
    s_waitcnt vmcnt(3)
L_dg59:
    s_waitcnt vmcnt(9)
    buffer_load_dwordx4 v[160:163], v2, s[24:27], s33 offen offset:2048 nt
    v_mfma_f32_16x16x32_bf16 v[32:35], v[24:27], v[96:99], v[32:35]
    s_waitcnt lgkmcnt(0)
    v_cmp_gt_u32 vcc, v23, v22
    v_sub_u32 v23, v22, v23
    v_add_u32 v23, -9, v23
    v_cmp_gt_u32 s[92:93], 32, v23
    v_mov_b32_dpp v21, v43 row_newbcast:6 row_mask:0xf bank_mask:0x3
    v_mov_b32_dpp v21, v43 row_newbcast:7 row_mask:0xf bank_mask:0xc
    v_and_b32 v24, v21, v28
    v_and_b32 v25, v21, v29
    v_and_b32 v26, v21, v30
    v_and_b32 v27, v21, v31
    s_cbranch_vccnz L_dg60
    s_waitcnt vmcnt(4)
    s_cmp_eq_u32 s92, 0
    s_cbranch_scc1 L_dg60
    s_waitcnt vmcnt(3)
L_dg60:
    s_waitcnt vmcnt(9)
    buffer_load_dwordx4 v[164:167], v2, s[24:27], s33 offen offset:3072 nt
    s_add_u32 s33, s33, 0x10000
    v_mfma_f32_16x16x32_bf16 v[32:35], v[24:27], v[100:103], v[32:35]
    v_mov_b32_dpp v21, v43 row_newbcast:8 row_mask:0xf bank_mask:0x3
    v_mov_b32_dpp v21, v43 row_newbcast:9 row_mask:0xf bank_mask:0xc
    v_and_b32 v24, v21, v28
    v_and_b32 v25, v21, v29
    v_and_b32 v26, v21, v30
    v_and_b32 v27, v21, v31
    s_cbranch_vccnz L_dg61
    s_waitcnt vmcnt(4)
    s_cmp_eq_u32 s92, 0
    s_cbranch_scc1 L_dg61
    s_waitcnt vmcnt(3)
L_dg61:
    s_waitcnt vmcnt(9)
    buffer_load_dwordx4 v[168:171], v2, s[24:27], s33 offen offset:0 nt
    v_mfma_f32_16x16x32_bf16 v[32:35], v[24:27], v[104:107], v[32:35]
    v_mov_b32_dpp v21, v43 row_newbcast:10 row_mask:0xf bank_mask:0x3
    v_mov_b32_dpp v21, v43 row_newbcast:11 row_mask:0xf bank_mask:0xc
    v_and_b32 v24, v21, v28
    v_and_b32 v25, v21, v29
    v_and_b32 v26, v21, v30
    v_and_b32 v27, v21, v31
    s_cbranch_vccnz L_dg62
    s_waitcnt vmcnt(4)
    s_cmp_eq_u32 s92, 0
    s_cbranch_scc1 L_dg62
    s_waitcnt vmcnt(3)
L_dg62:
    s_waitcnt vmcnt(9)
    buffer_load_dwordx4 v[172:175], v2, s[24:27], s33 offen offset:1024 nt
    v_mfma_f32_16x16x32_bf16 v[32:35], v[24:27], v[108:111], v[32:35]
    v_add_u32 v22, 4, v22
    ds_write_b32 v3, v22 offset:58368
    ds_read_b32 v23, v3 offset:59392
    v_mov_b32_dpp v21, v43 row_newbcast:12 row_mask:0xf bank_mask:0x3
    v_mov_b32_dpp v21, v43 row_newbcast:13 row_mask:0xf bank_mask:0xc
    v_and_b32 v24, v21, v28
    v_and_b32 v25, v21, v29
    v_and_b32 v26, v21, v30
    v_and_b32 v27, v21, v31
    s_cbranch_vccnz L_dg63
    s_waitcnt vmcnt(4)
    s_cmp_eq_u32 s92, 0
    s_cbranch_scc1 L_dg63
    s_waitcnt vmcnt(3)
L_dg63:
    s_waitcnt vmcnt(9)
    buffer_load_dwordx4 v[176:179], v2, s[24:27], s33 offen offset:2048 nt
    v_mfma_f32_16x16x32_bf16 v[32:35], v[24:27], v[112:115], v[32:35]
    s_waitcnt lgkmcnt(0)
    v_cmp_gt_u32 vcc, v23, v22
    v_sub_u32 v23, v22, v23
    v_add_u32 v23, -9, v23
    v_cmp_gt_u32 s[92:93], 32, v23
    v_mov_b32_dpp v21, v43 row_newbcast:14 row_mask:0xf bank_mask:0x3
    v_mov_b32_dpp v21, v43 row_newbcast:15 row_mask:0xf bank_mask:0xc
    v_and_b32 v24, v21, v28
    v_and_b32 v25, v21, v29
    v_and_b32 v26, v21, v30
    v_and_b32 v27, v21, v31
    s_cbranch_vccnz L_dg64
    s_waitcnt vmcnt(4)
    s_cmp_eq_u32 s92, 0
    s_cbranch_scc1 L_dg64
    s_waitcnt vmcnt(3)
L_dg64:
    s_waitcnt vmcnt(9)
    buffer_load_dwordx4 v[180:183], v2, s[24:27], s33 offen offset:3072 nt
    s_add_u32 s33, s33, 0x10000
    v_mfma_f32_16x16x32_bf16 v[32:35], v[24:27], v[116:119], v[32:35]
    v_mov_b32_dpp v21, v44 row_newbcast:0 row_mask:0xf bank_mask:0x3
    v_mov_b32_dpp v21, v44 row_newbcast:1 row_mask:0xf bank_mask:0xc
    v_and_b32 v24, v21, v28
    v_and_b32 v25, v21, v29
    v_and_b32 v26, v21, v30
    v_and_b32 v27, v21, v31
    s_cbranch_vccnz L_dg65
    s_waitcnt vmcnt(4)
    s_cmp_eq_u32 s92, 0
    s_cbranch_scc1 L_dg65
    s_waitcnt vmcnt(3)
L_dg65:
    s_waitcnt vmcnt(9)
    buffer_load_dwordx4 v[56:59], v2, s[24:27], s33 offen offset:0 nt
    v_mfma_f32_16x16x32_bf16 v[32:35], v[24:27], v[120:123], v[32:35]
    v_mov_b32_dpp v21, v44 row_newbcast:2 row_mask:0xf bank_mask:0x3
    v_mov_b32_dpp v21, v44 row_newbcast:3 row_mask:0xf bank_mask:0xc
    v_and_b32 v24, v21, v28
    v_and_b32 v25, v21, v29
    v_and_b32 v26, v21, v30
    v_and_b32 v27, v21, v31
    s_cbranch_vccnz L_dg66
    s_waitcnt vmcnt(4)
    s_cmp_eq_u32 s92, 0
    s_cbranch_scc1 L_dg66
    s_waitcnt vmcnt(3)
L_dg66:
    s_waitcnt vmcnt(9)
    buffer_load_dwordx4 v[60:63], v2, s[24:27], s33 offen offset:1024 nt
    v_mfma_f32_16x16x32_bf16 v[32:35], v[24:27], v[124:127], v[32:35]
    v_add_u32 v22, 4, v22
    ds_write_b32 v3, v22 offset:58368
    ds_read_b32 v23, v3 offset:59392
    v_mov_b32_dpp v21, v44 row_newbcast:4 row_mask:0xf bank_mask:0x3
    v_mov_b32_dpp v21, v44 row_newbcast:5 row_mask:0xf bank_mask:0xc
    v_and_b32 v24, v21, v28
    v_and_b32 v25, v21, v29
    v_and_b32 v26, v21, v30
    v_and_b32 v27, v21, v31
    s_cbranch_vccnz L_dg67
    s_waitcnt vmcnt(4)
    s_cmp_eq_u32 s92, 0
    s_cbranch_scc1 L_dg67
    s_waitcnt vmcnt(3)
L_dg67:
    s_waitcnt vmcnt(9)
    buffer_load_dwordx4 v[64:67], v2, s[24:27], s33 offen offset:2048 nt
    v_mfma_f32_16x16x32_bf16 v[32:35], v[24:27], v[128:131], v[32:35]
    s_waitcnt lgkmcnt(0)
    v_cmp_gt_u32 vcc, v23, v22
    v_sub_u32 v23, v22, v23
    v_add_u32 v23, -9, v23
    v_cmp_gt_u32 s[92:93], 32, v23
    v_mov_b32_dpp v21, v44 row_newbcast:6 row_mask:0xf bank_mask:0x3
    v_mov_b32_dpp v21, v44 row_newbcast:7 row_mask:0xf bank_mask:0xc
    v_and_b32 v24, v21, v28
    v_and_b32 v25, v21, v29
    v_and_b32 v26, v21, v30
    v_and_b32 v27, v21, v31
    s_cbranch_vccnz L_dg68
    s_waitcnt vmcnt(4)
    s_cmp_eq_u32 s92, 0
    s_cbranch_scc1 L_dg68
    s_waitcnt vmcnt(3)
L_dg68:
    s_waitcnt vmcnt(9)
    buffer_load_dwordx4 v[68:71], v2, s[24:27], s33 offen offset:3072 nt
    s_add_u32 s33, s33, 0x10000
    v_mfma_f32_16x16x32_bf16 v[32:35], v[24:27], v[132:135], v[32:35]
    v_mov_b32_dpp v21, v44 row_newbcast:8 row_mask:0xf bank_mask:0x3
    v_mov_b32_dpp v21, v44 row_newbcast:9 row_mask:0xf bank_mask:0xc
    v_and_b32 v24, v21, v28
    v_and_b32 v25, v21, v29
    v_and_b32 v26, v21, v30
    v_and_b32 v27, v21, v31
    s_cbranch_vccnz L_dg69
    s_waitcnt vmcnt(4)
    s_cmp_eq_u32 s92, 0
    s_cbranch_scc1 L_dg69
    s_waitcnt vmcnt(3)
L_dg69:
    s_waitcnt vmcnt(9)
    buffer_load_dwordx4 v[72:75], v2, s[24:27], s33 offen offset:0 nt
    v_mfma_f32_16x16x32_bf16 v[32:35], v[24:27], v[136:139], v[32:35]
    v_mov_b32_dpp v21, v44 row_newbcast:10 row_mask:0xf bank_mask:0x3
    v_mov_b32_dpp v21, v44 row_newbcast:11 row_mask:0xf bank_mask:0xc
    v_and_b32 v24, v21, v28
    v_and_b32 v25, v21, v29
    v_and_b32 v26, v21, v30
    v_and_b32 v27, v21, v31
    s_cbranch_vccnz L_dg70
    s_waitcnt vmcnt(4)
    s_cmp_eq_u32 s92, 0
    s_cbranch_scc1 L_dg70
    s_waitcnt vmcnt(3)
L_dg70:
    s_waitcnt vmcnt(9)
    buffer_load_dwordx4 v[76:79], v2, s[24:27], s33 offen offset:1024 nt
    v_mfma_f32_16x16x32_bf16 v[32:35], v[24:27], v[140:143], v[32:35]
    v_add_u32 v22, 4, v22
    ds_write_b32 v3, v22 offset:58368
    ds_read_b32 v23, v3 offset:59392
    v_mov_b32_dpp v21, v44 row_newbcast:12 row_mask:0xf bank_mask:0x3
    v_mov_b32_dpp v21, v44 row_newbcast:13 row_mask:0xf bank_mask:0xc
    v_and_b32 v24, v21, v28
    v_and_b32 v25, v21, v29
    v_and_b32 v26, v21, v30
    v_and_b32 v27, v21, v31
    s_cbranch_vccnz L_dg71
    s_waitcnt vmcnt(4)
    s_cmp_eq_u32 s92, 0
    s_cbranch_scc1 L_dg71
    s_waitcnt vmcnt(3)
L_dg71:
    s_waitcnt vmcnt(9)
    buffer_load_dwordx4 v[80:83], v2, s[24:27], s33 offen offset:2048 nt
    v_mfma_f32_16x16x32_bf16 v[32:35], v[24:27], v[144:147], v[32:35]
    s_waitcnt lgkmcnt(0)
    v_cmp_gt_u32 vcc, v23, v22
    v_sub_u32 v23, v22, v23
    v_add_u32 v23, -9, v23
    v_cmp_gt_u32 s[92:93], 32, v23
    v_mov_b32_dpp v21, v44 row_newbcast:14 row_mask:0xf bank_mask:0x3
    v_mov_b32_dpp v21, v44 row_newbcast:15 row_mask:0xf bank_mask:0xc
    v_and_b32 v24, v21, v28
    v_and_b32 v25, v21, v29
    v_and_b32 v26, v21, v30
    v_and_b32 v27, v21, v31
    s_cbranch_vccnz L_dg72
    s_waitcnt vmcnt(4)
    s_cmp_eq_u32 s92, 0
    s_cbranch_scc1 L_dg72
    s_waitcnt vmcnt(3)
L_dg72:
    s_waitcnt vmcnt(9)
    buffer_load_dwordx4 v[84:87], v2, s[24:27], s33 offen offset:3072 nt
    s_add_u32 s33, s33, 0x10000
    v_mfma_f32_16x16x32_bf16 v[32:35], v[24:27], v[148:151], v[32:35]
    v_mov_b32_dpp v21, v45 row_newbcast:0 row_mask:0xf bank_mask:0x3
    v_mov_b32_dpp v21, v45 row_newbcast:1 row_mask:0xf bank_mask:0xc
    v_and_b32 v24, v21, v28
    v_and_b32 v25, v21, v29
    v_and_b32 v26, v21, v30
    v_and_b32 v27, v21, v31
    s_cbranch_vccnz L_dg73
    s_waitcnt vmcnt(4)
    s_cmp_eq_u32 s92, 0
    s_cbranch_scc1 L_dg73
    s_waitcnt vmcnt(3)
L_dg73:
    s_waitcnt vmcnt(9)
    buffer_load_dwordx4 v[88:91], v2, s[24:27], s33 offen offset:0 nt
    v_mfma_f32_16x16x32_bf16 v[32:35], v[24:27], v[152:155], v[32:35]
    v_mov_b32_dpp v21, v45 row_newbcast:2 row_mask:0xf bank_mask:0x3
    v_mov_b32_dpp v21, v45 row_newbcast:3 row_mask:0xf bank_mask:0xc
    v_and_b32 v24, v21, v28
    v_and_b32 v25, v21, v29
    v_and_b32 v26, v21, v30
    v_and_b32 v27, v21, v31
    s_cbranch_vccnz L_dg74
    s_waitcnt vmcnt(4)
    s_cmp_eq_u32 s92, 0
    s_cbranch_scc1 L_dg74
    s_waitcnt vmcnt(3)
L_dg74:
    s_waitcnt vmcnt(9)
    buffer_load_dwordx4 v[92:95], v2, s[24:27], s33 offen offset:1024 nt
    v_mfma_f32_16x16x32_bf16 v[32:35], v[24:27], v[156:159], v[32:35]
    v_add_u32 v22, 4, v22
    ds_write_b32 v3, v22 offset:58368
    ds_read_b32 v23, v3 offset:59392
    v_mov_b32_dpp v21, v45 row_newbcast:4 row_mask:0xf bank_mask:0x3
    v_mov_b32_dpp v21, v45 row_newbcast:5 row_mask:0xf bank_mask:0xc
    v_and_b32 v24, v21, v28
    v_and_b32 v25, v21, v29
    v_and_b32 v26, v21, v30
    v_and_b32 v27, v21, v31
    s_cbranch_vccnz L_dg75
    s_waitcnt vmcnt(4)
    s_cmp_eq_u32 s92, 0
    s_cbranch_scc1 L_dg75
    s_waitcnt vmcnt(3)
L_dg75:
    s_waitcnt vmcnt(9)
    buffer_load_dwordx4 v[96:99], v2, s[24:27], s33 offen offset:2048 nt
    v_mfma_f32_16x16x32_bf16 v[32:35], v[24:27], v[160:163], v[32:35]
    s_waitcnt lgkmcnt(0)
    v_cmp_gt_u32 vcc, v23, v22
    v_sub_u32 v23, v22, v23
    v_add_u32 v23, -9, v23
    v_cmp_gt_u32 s[92:93], 32, v23
    v_mov_b32_dpp v21, v45 row_newbcast:6 row_mask:0xf bank_mask:0x3
    v_mov_b32_dpp v21, v45 row_newbcast:7 row_mask:0xf bank_mask:0xc
    v_and_b32 v24, v21, v28
    v_and_b32 v25, v21, v29
    v_and_b32 v26, v21, v30
    v_and_b32 v27, v21, v31
    s_cbranch_vccnz L_dg76
    s_waitcnt vmcnt(4)
    s_cmp_eq_u32 s92, 0
    s_cbranch_scc1 L_dg76
    s_waitcnt vmcnt(3)
L_dg76:
    s_waitcnt vmcnt(9)
    buffer_load_dwordx4 v[100:103], v2, s[24:27], s33 offen offset:3072 nt
    s_add_u32 s33, s33, 0x10000
    v_mfma_f32_16x16x32_bf16 v[32:35], v[24:27], v[164:167], v[32:35]
    v_mov_b32_dpp v21, v45 row_newbcast:8 row_mask:0xf bank_mask:0x3
    v_mov_b32_dpp v21, v45 row_newbcast:9 row_mask:0xf bank_mask:0xc
    v_and_b32 v24, v21, v28
    v_and_b32 v25, v21, v29
    v_and_b32 v26, v21, v30
    v_and_b32 v27, v21, v31
    s_cbranch_vccnz L_dg77
    s_waitcnt vmcnt(4)
    s_cmp_eq_u32 s92, 0
    s_cbranch_scc1 L_dg77
    s_waitcnt vmcnt(3)
L_dg77:
    s_waitcnt vmcnt(9)
    buffer_load_dwordx4 v[104:107], v2, s[24:27], s33 offen offset:0 nt
    v_mfma_f32_16x16x32_bf16 v[32:35], v[24:27], v[168:171], v[32:35]
    v_mov_b32_dpp v21, v45 row_newbcast:10 row_mask:0xf bank_mask:0x3
    v_mov_b32_dpp v21, v45 row_newbcast:11 row_mask:0xf bank_mask:0xc
    v_and_b32 v24, v21, v28
    v_and_b32 v25, v21, v29
    v_and_b32 v26, v21, v30
    v_and_b32 v27, v21, v31
    s_cbranch_vccnz L_dg78
    s_waitcnt vmcnt(4)
    s_cmp_eq_u32 s92, 0
    s_cbranch_scc1 L_dg78
    s_waitcnt vmcnt(3)
L_dg78:
    s_waitcnt vmcnt(9)
    buffer_load_dwordx4 v[108:111], v2, s[24:27], s33 offen offset:1024 nt
    v_mfma_f32_16x16x32_bf16 v[32:35], v[24:27], v[172:175], v[32:35]
    v_add_u32 v22, 4, v22
    ds_write_b32 v3, v22 offset:58368
    ds_read_b32 v23, v3 offset:59392
    v_mov_b32_dpp v21, v45 row_newbcast:12 row_mask:0xf bank_mask:0x3
    v_mov_b32_dpp v21, v45 row_newbcast:13 row_mask:0xf bank_mask:0xc
    v_and_b32 v24, v21, v28
    v_and_b32 v25, v21, v29
    v_and_b32 v26, v21, v30
    v_and_b32 v27, v21, v31
    s_cbranch_vccnz L_dg79
    s_waitcnt vmcnt(4)
    s_cmp_eq_u32 s92, 0
    s_cbranch_scc1 L_dg79
    s_waitcnt vmcnt(3)
L_dg79:
    s_waitcnt vmcnt(9)
    buffer_load_dwordx4 v[112:115], v2, s[24:27], s33 offen offset:2048 nt
    v_mfma_f32_16x16x32_bf16 v[32:35], v[24:27], v[176:179], v[32:35]
    s_waitcnt lgkmcnt(0)
    v_cmp_gt_u32 vcc, v23, v22
    v_sub_u32 v23, v22, v23
    v_add_u32 v23, -9, v23
    v_cmp_gt_u32 s[92:93], 32, v23
    v_mov_b32_dpp v21, v45 row_newbcast:14 row_mask:0xf bank_mask:0x3
    v_mov_b32_dpp v21, v45 row_newbcast:15 row_mask:0xf bank_mask:0xc
    v_and_b32 v24, v21, v28
    v_and_b32 v25, v21, v29
    v_and_b32 v26, v21, v30
    v_and_b32 v27, v21, v31
    s_cbranch_vccnz L_dg80
    s_waitcnt vmcnt(4)
    s_cmp_eq_u32 s92, 0
    s_cbranch_scc1 L_dg80
    s_waitcnt vmcnt(3)
L_dg80:
    s_waitcnt vmcnt(9)
    buffer_load_dwordx4 v[116:119], v2, s[24:27], s33 offen offset:3072 nt
    s_add_u32 s33, s33, 0x10000
    v_mfma_f32_16x16x32_bf16 v[32:35], v[24:27], v[180:183], v[32:35]
    v_mov_b32 v40, v44
    v_mov_b32 v41, v45
    v_mov_b32 v42, v46
    v_mov_b32 v43, v47
    v_mov_b32 v44, v48
    v_mov_b32 v45, v49
    v_mov_b32 v46, v50
    v_mov_b32 v47, v51
    v_mov_b32 v48, v52
    v_mov_b32 v49, v53
    v_mov_b32 v50, v54
    v_mov_b32 v51, v55
    s_add_u32 s29, s29, 1
    s_cmp_lt_u32 s29, 3
    s_cbranch_scc1 L_vloop
L_tailcode:
    s_mov_b32 m0, s46
    s_add_u32 s46, s46, 1024
    buffer_load_dwordx4 v184, s[36:39], s45 offen nt lds
    s_add_u32 s45, s45, s94
    s_mov_b32 m0, s46
    s_add_u32 s46, s46, 1024
    buffer_load_dwordx4 v184, s[36:39], s45 offen nt lds
    s_add_u32 s45, s45, s94
    v_mov_b32_dpp v21, v42 row_newbcast:0 row_mask:0xf bank_mask:0x3
    v_mov_b32_dpp v21, v42 row_newbcast:1 row_mask:0xf bank_mask:0xc
    v_and_b32 v24, v21, v28
    v_and_b32 v25, v21, v29
    v_and_b32 v26, v21, v30
    v_and_b32 v27, v21, v31
    s_nop 1
    v_mfma_f32_16x16x32_bf16 v[32:35], v[24:27], v[56:59], v[32:35]
    v_mov_b32_dpp v21, v42 row_newbcast:2 row_mask:0xf bank_mask:0x3
    v_mov_b32_dpp v21, v42 row_newbcast:3 row_mask:0xf bank_mask:0xc
    v_and_b32 v24, v21, v28
    v_and_b32 v25, v21, v29
    v_and_b32 v26, v21, v30
    v_and_b32 v27, v21, v31
    s_nop 1
    v_mfma_f32_16x16x32_bf16 v[32:35], v[24:27], v[60:63], v[32:35]
    v_mov_b32_dpp v21, v42 row_newbcast:4 row_mask:0xf bank_mask:0x3
    v_mov_b32_dpp v21, v42 row_newbcast:5 row_mask:0xf bank_mask:0xc
    v_and_b32 v24, v21, v28
    v_and_b32 v25, v21, v29
    v_and_b32 v26, v21, v30
    v_and_b32 v27, v21, v31
    s_nop 1
    v_mfma_f32_16x16x32_bf16 v[32:35], v[24:27], v[64:67], v[32:35]
    v_mov_b32_dpp v21, v42 row_newbcast:6 row_mask:0xf bank_mask:0x3
    v_mov_b32_dpp v21, v42 row_newbcast:7 row_mask:0xf bank_mask:0xc
    v_and_b32 v24, v21, v28
    v_and_b32 v25, v21, v29
    v_and_b32 v26, v21, v30
    v_and_b32 v27, v21, v31
    s_nop 1
    v_mfma_f32_16x16x32_bf16 v[32:35], v[24:27], v[68:71], v[32:35]
    v_mov_b32_dpp v21, v42 row_newbcast:8 row_mask:0xf bank_mask:0x3
    v_mov_b32_dpp v21, v42 row_newbcast:9 row_mask:0xf bank_mask:0xc
    v_and_b32 v24, v21, v28
    v_and_b32 v25, v21, v29
    v_and_b32 v26, v21, v30
    v_and_b32 v27, v21, v31
    s_nop 1
    v_mfma_f32_16x16x32_bf16 v[32:35], v[24:27], v[72:75], v[32:35]
    v_mov_b32_dpp v21, v42 row_newbcast:10 row_mask:0xf bank_mask:0x3
    v_mov_b32_dpp v21, v42 row_newbcast:11 row_mask:0xf bank_mask:0xc
    v_and_b32 v24, v21, v28
    v_and_b32 v25, v21, v29
    v_and_b32 v26, v21, v30
    v_and_b32 v27, v21, v31
    s_nop 1
    v_mfma_f32_16x16x32_bf16 v[32:35], v[24:27], v[76:79], v[32:35]
    v_mov_b32_dpp v21, v42 row_newbcast:12 row_mask:0xf bank_mask:0x3
    v_mov_b32_dpp v21, v42 row_newbcast:13 row_mask:0xf bank_mask:0xc
    v_and_b32 v24, v21, v28
    v_and_b32 v25, v21, v29
    v_and_b32 v26, v21, v30
    v_and_b32 v27, v21, v31
    s_waitcnt vmcnt(11)
    s_nop 0
    v_mfma_f32_16x16x32_bf16 v[32:35], v[24:27], v[80:83], v[32:35]
    v_mov_b32_dpp v21, v42 row_newbcast:14 row_mask:0xf bank_mask:0x3
    v_mov_b32_dpp v21, v42 row_newbcast:15 row_mask:0xf bank_mask:0xc
    v_and_b32 v24, v21, v28
    v_and_b32 v25, v21, v29
    v_and_b32 v26, v21, v30
    v_and_b32 v27, v21, v31
    s_waitcnt vmcnt(10)
    s_nop 0
    v_mfma_f32_16x16x32_bf16 v[32:35], v[24:27], v[84:87], v[32:35]
    v_mov_b32_dpp v21, v43 row_newbcast:0 row_mask:0xf bank_mask:0x3
    v_mov_b32_dpp v21, v43 row_newbcast:1 row_mask:0xf bank_mask:0xc
    v_and_b32 v24, v21, v28
    v_and_b32 v25, v21, v29
    v_and_b32 v26, v21, v30
    v_and_b32 v27, v21, v31
    s_waitcnt vmcnt(9)
    s_nop 0
    v_mfma_f32_16x16x32_bf16 v[32:35], v[24:27], v[88:91], v[32:35]
    v_mov_b32_dpp v21, v43 row_newbcast:2 row_mask:0xf bank_mask:0x3
    v_mov_b32_dpp v21, v43 row_newbcast:3 row_mask:0xf bank_mask:0xc
    v_and_b32 v24, v21, v28
    v_and_b32 v25, v21, v29
    v_and_b32 v26, v21, v30
    v_and_b32 v27, v21, v31
    s_waitcnt vmcnt(8)
    s_nop 0
    v_mfma_f32_16x16x32_bf16 v[32:35], v[24:27], v[92:95], v[32:35]
    v_mov_b32_dpp v21, v43 row_newbcast:4 row_mask:0xf bank_mask:0x3
    v_mov_b32_dpp v21, v43 row_newbcast:5 row_mask:0xf bank_mask:0xc
    v_and_b32 v24, v21, v28
    v_and_b32 v25, v21, v29
    v_and_b32 v26, v21, v30
    v_and_b32 v27, v21, v31
    s_waitcnt vmcnt(7)
    s_nop 0
    v_mfma_f32_16x16x32_bf16 v[32:35], v[24:27], v[96:99], v[32:35]
    v_mov_b32_dpp v21, v43 row_newbcast:6 row_mask:0xf bank_mask:0x3
    v_mov_b32_dpp v21, v43 row_newbcast:7 row_mask:0xf bank_mask:0xc
    v_and_b32 v24, v21, v28
    v_and_b32 v25, v21, v29
    v_and_b32 v26, v21, v30
    v_and_b32 v27, v21, v31
    s_waitcnt vmcnt(6)
    s_nop 0
    v_mfma_f32_16x16x32_bf16 v[32:35], v[24:27], v[100:103], v[32:35]
    s_mov_b32 m0, s46
    s_add_u32 s46, s46, 1024
    buffer_load_dwordx4 v185, s[36:39], s45 offen nt lds
    s_add_u32 s45, s45, s94
    v_mov_b32_dpp v21, v43 row_newbcast:8 row_mask:0xf bank_mask:0x3
    v_mov_b32_dpp v21, v43 row_newbcast:9 row_mask:0xf bank_mask:0xc
    v_and_b32 v24, v21, v28
    v_and_b32 v25, v21, v29
    v_and_b32 v26, v21, v30
    v_and_b32 v27, v21, v31
    s_waitcnt vmcnt(6)
    s_nop 0
    v_mfma_f32_16x16x32_bf16 v[32:35], v[24:27], v[104:107], v[32:35]
    s_mov_b32 m0, s46
    s_add_u32 s46, s46, 1024
    buffer_load_dwordx4 v185, s[36:39], s45 offen nt lds
    s_add_u32 s45, s45, s94
    v_mov_b32_dpp v21, v43 row_newbcast:10 row_mask:0xf bank_mask:0x3
    v_mov_b32_dpp v21, v43 row_newbcast:11 row_mask:0xf bank_mask:0xc
    v_and_b32 v24, v21, v28
    v_and_b32 v25, v21, v29
    v_and_b32 v26, v21, v30
    v_and_b32 v27, v21, v31
    s_waitcnt vmcnt(6)
    s_nop 0
    v_mfma_f32_16x16x32_bf16 v[32:35], v[24:27], v[108:111], v[32:35]
    s_mov_b32 m0, s46
    s_add_u32 s46, s46, 1024
    buffer_load_dwordx4 v184, s[36:39], s45 offen nt lds
    s_add_u32 s45, s45, s94
    v_mov_b32_dpp v21, v43 row_newbcast:12 row_mask:0xf bank_mask:0x3
    v_mov_b32_dpp v21, v43 row_newbcast:13 row_mask:0xf bank_mask:0xc
    v_and_b32 v24, v21, v28
    v_and_b32 v25, v21, v29
    v_and_b32 v26, v21, v30
    v_and_b32 v27, v21, v31
    s_waitcnt vmcnt(6)
    s_nop 0
    v_mfma_f32_16x16x32_bf16 v[32:35], v[24:27], v[112:115], v[32:35]
    s_mov_b32 m0, s46
    s_add_u32 s46, s46, 1024
    buffer_load_dwordx4 v184, s[36:39], s45 offen nt lds
    s_add_u32 s45, s45, s94
    v_mov_b32_dpp v21, v43 row_newbcast:14 row_mask:0xf bank_mask:0x3
    v_mov_b32_dpp v21, v43 row_newbcast:15 row_mask:0xf bank_mask:0xc
    v_and_b32 v24, v21, v28
    v_and_b32 v25, v21, v29
    v_and_b32 v26, v21, v30
    v_and_b32 v27, v21, v31
    s_waitcnt vmcnt(6)
    s_nop 0
    v_mfma_f32_16x16x32_bf16 v[32:35], v[24:27], v[116:119], v[32:35]
    s_mov_b32 m0, s46
    s_add_u32 s46, s46, 1024
    buffer_load_dwordx4 v185, s[36:39], s45 offen nt lds
    s_add_u32 s45, s45, s94
    s_mov_b32 m0, s46
    s_add_u32 s46, s46, 1024
    buffer_load_dwordx4 v185, s[36:39], s45 offen nt lds
    s_add_u32 s45, s45, s94
L_fdone:
    s_cmp_ge_u32 s2, 144
    s_nop 6
    ds_write_b128 v190, v[32:35] offset:54272
    s_waitcnt lgkmcnt(0)
    s_barrier
    s_cbranch_scc1 L_notproj
    s_barrier
    buffer_load_dwordx4 v[120:123], v2, s[40:43], s44 offen offset:0 sc1
    buffer_load_dwordx4 v[124:127], v2, s[40:43], s44 offen offset:1024 sc1
    s_mov_b32 s48, 0
    s_waitcnt vmcnt(2)
    s_barrier
    ds_read_b64_tr_b16 v[56:57], v186 offset:20480
    ds_read_b64_tr_b16 v[58:59], v186 offset:21504
    ds_read_b64_tr_b16 v[60:61], v186 offset:28672
    ds_read_b64_tr_b16 v[62:63], v186 offset:29696
    ds_read_b64_tr_b16 v[64:65], v186 offset:20992
    ds_read_b64_tr_b16 v[66:67], v186 offset:22016
    ds_read_b64_tr_b16 v[68:69], v186 offset:29184
    ds_read_b64_tr_b16 v[70:71], v186 offset:30208
    ds_read_b64_tr_b16 v[72:73], v187 offset:20480
    ds_read_b64_tr_b16 v[74:75], v187 offset:21504
    ds_read_b64_tr_b16 v[76:77], v187 offset:28672
    ds_read_b64_tr_b16 v[78:79], v187 offset:29696
    ds_read_b64_tr_b16 v[80:81], v187 offset:20992
    ds_read_b64_tr_b16 v[82:83], v187 offset:22016
    ds_read_b64_tr_b16 v[84:85], v187 offset:29184
    ds_read_b64_tr_b16 v[86:87], v187 offset:30208
    s_branch L_ochk
.p2align 3
L_opoll:
    buffer_load_dwordx4 v[120:123], v2, s[40:43], s44 offen offset:0 sc1
    buffer_load_dwordx4 v[124:127], v2, s[40:43], s44 offen offset:1024 sc1
L_ochk:
    s_add_u32 s48, s48, 1
    s_cmp_ge_u32 s48, 1048576
    s_cbranch_scc1 L_ook
    s_waitcnt vmcnt(1)
    v_max3_u32 v20, v120, v121, v122
    s_waitcnt vmcnt(0)
    v_max3_u32 v21, v124, v125, v126
    v_max3_u32 v20, v20, v123, v127
    v_max_u32 v20, v20, v21
    v_cmp_eq_u32 vcc, -1, v20
    s_and_b64 exec, exec, vcc
    s_cbranch_scc1 L_opoll
L_ook:
    s_mov_b64 exec, -1
    ds_write_b128 v191, v[120:123] offset:0
    ds_write_b128 v191, v[124:127] offset:1056
    s_waitcnt lgkmcnt(0)
L_ostaged:
    s_barrier
    ds_read_b128 v[88:91], v188 offset:0
    ds_read_b128 v[92:95], v188 offset:64
    ds_read_b128 v[96:99], v188 offset:128
    ds_read_b128 v[100:103], v188 offset:192
    ds_read_b128 v[104:107], v188 offset:256
    ds_read_b128 v[108:111], v188 offset:320
    ds_read_b128 v[112:115], v188 offset:384
    ds_read_b128 v[116:119], v188 offset:448
    s_waitcnt lgkmcnt(7)
    v_mfma_f32_16x16x32_bf16 v[12:15], v[88:91], v[56:59], 0
    s_waitcnt lgkmcnt(6)
    v_mfma_f32_16x16x32_bf16 v[12:15], v[92:95], v[60:63], v[12:15]
    s_waitcnt lgkmcnt(5)
    v_mfma_f32_16x16x32_bf16 v[12:15], v[96:99], v[64:67], v[12:15]
    s_waitcnt lgkmcnt(4)
    v_mfma_f32_16x16x32_bf16 v[12:15], v[100:103], v[68:71], v[12:15]
    s_waitcnt lgkmcnt(3)
    v_mfma_f32_16x16x32_bf16 v[12:15], v[104:107], v[72:75], v[12:15]
    s_waitcnt lgkmcnt(2)
    v_mfma_f32_16x16x32_bf16 v[12:15], v[108:111], v[76:79], v[12:15]
    s_waitcnt lgkmcnt(1)
    v_mfma_f32_16x16x32_bf16 v[12:15], v[112:115], v[80:83], v[12:15]
    s_waitcnt lgkmcnt(0)
    v_mfma_f32_16x16x32_bf16 v[12:15], v[116:119], v[84:87], v[12:15]
    v_mov_b32 v17, s34
    v_mov_b32 v19, s34
    s_mov_b32 s48, 0x55555555
    s_nop 4
    v_add_f32 v12, v12, v13
    v_add_f32 v14, v14, v15
    v_add_f32 v16, v12, v14
    s_nop 1
    v_mov_b32_dpp v18, v16 quad_perm:[1,1,3,3] row_mask:0xf bank_mask:0xf
    s_mov_b32 exec_lo, s48
    s_mov_b32 exec_hi, s48
    buffer_store_dwordx4 v[16:19], v189, s[40:43], s47 offen sc1
    s_endpgm
L_notproj:
    s_cmp_ge_u32 s2, 180
    s_cbranch_scc1 L_end
    s_barrier
    s_mov_b32 s48, 0
    s_mov_b32 s36, s14
    s_mov_b32 s37, s15
    s_mov_b32 s38, 4608
    s_and_b32 s45, s35, 3
    s_mul_i32 s45, s45, 1152
    s_lshr_b32 s31, s35, 2
    s_lshl_b32 s31, s31, 7
    s_add_u32 s45, s45, s31
    s_lshl_b32 s31, s3, 5
    s_add_u32 s45, s45, s31
.p2align 3
L_ppoll:
    buffer_load_dwordx4 v[12:15], v188, s[40:43], s44 offen sc1
    buffer_load_dwordx4 v[16:19], v188, s[40:43], s47 offen sc1
    s_add_u32 s48, s48, 1
    s_cmp_ge_u32 s48, 1048576
    s_cbranch_scc1 L_pok
    s_waitcnt vmcnt(1)
    v_xor_b32 v20, s34, v13
    v_xor_b32 v21, s34, v15
    s_waitcnt vmcnt(0)
    v_xor_b32 v22, s34, v17
    v_xor_b32 v23, s34, v19
    v_or3_b32 v20, v20, v21, v22
    v_or_b32 v20, v20, v23
    v_cmp_ne_u32 vcc, 0, v20
    s_and_b64 exec, exec, vcc
    s_cbranch_scc1 L_ppoll
L_pok:
    s_mov_b64 exec, -1
    s_waitcnt vmcnt(0)
    v_add_f32 v12, v12, v16
    v_add_f32 v14, v14, v18
    s_nop 0
    v_add_f32_dpp v12, v12, v12 row_ror:8 row_mask:0xf bank_mask:0xf
    v_add_f32_dpp v14, v14, v14 row_ror:8 row_mask:0xf bank_mask:0xf
    s_nop 1
    v_permlane16_swap_b32 v12, v14
    v_add_f32 v12, v12, v14
    v_mov_b32 v14, v12
    s_nop 1
    v_permlane32_swap_b32 v12, v14
    v_add_f32 v12, v12, v14
    v_cvt_pk_bf16_f32 v12, v12, v12
    s_mov_b64 exec, 0x00ff00ff
    buffer_store_short v12, v189, s[36:39], s45 offen
    s_add_u32 s48, s2, s3
    s_cmp_lg_u32 s48, 144
    s_cbranch_scc1 L_end
    v_mov_b32 v4, s34
    v_mov_b32 v6, 0
    s_mov_b64 exec, 1
    buffer_store_dword v4, v6, s[40:43], 0 offen
    s_endpgm
L_helper:
    s_and_b32 s40, s32, 63
    s_lshr_b32 s35, s32, 6
    v_lshrrev_b32 v1, 3, v0
    v_lshlrev_b32 v1, 13, v1
    v_and_b32 v2, 7, v0
    v_lshl_add_u32 v1, v2, 4, v1
    s_mul_i32 s42, s35, 1179648
    s_lshl_b32 s41, s40, 7
    s_add_u32 s42, s42, s41
    v_and_b32 v2, 3, v0
    v_mul_u32_u24 v2, 1152, v2
    v_lshrrev_b32 v3, 4, v0
    v_lshl_add_u32 v7, v3, 3, v2
    v_lshl_add_u32 v2, v3, 4, v2
    s_mul_i32 s43, s35, 288
    s_waitcnt lgkmcnt(0)
    s_load_dword s34, s[18:19], 0
    s_mov_b32 s24, s4
    s_mov_b32 s25, s5
    s_mov_b32 s26, 0x1200
    s_mov_b32 s27, 0x20000
    buffer_load_dwordx4 v[16:19], v2, s[24:27], s43 offen offset:0
    buffer_load_dwordx4 v[20:23], v2, s[24:27], s43 offen offset:64
    buffer_load_dwordx4 v[24:27], v2, s[24:27], s43 offen offset:128
    buffer_load_dwordx4 v[28:31], v2, s[24:27], s43 offen offset:192
    buffer_load_dwordx2 v[32:33], v7, s[24:27], s43 offen offset:256
    s_mov_b32 s20, s10
    s_mov_b32 s21, s11
    s_mov_b32 s22, 0x480000
    s_mov_b32 s23, 0x20000
    s_mov_b32 m0, 0
    s_nop 0
    buffer_load_dwordx4 v1, s[20:23], s42 offen nt lds
    s_mov_b32 m0, 1024
    s_add_u32 s42, s42, 0x10000
    buffer_load_dwordx4 v1, s[20:23], s42 offen nt lds
    s_mov_b32 m0, 2048
    s_add_u32 s42, s42, 0x10000
    buffer_load_dwordx4 v1, s[20:23], s42 offen nt lds
    s_mov_b32 m0, 3072
    s_add_u32 s42, s42, 0x10000
    buffer_load_dwordx4 v1, s[20:23], s42 offen nt lds
    s_mov_b32 m0, 4096
    s_add_u32 s42, s42, 0x10000
    buffer_load_dwordx4 v1, s[20:23], s42 offen nt lds
    s_mov_b32 m0, 5120
    s_add_u32 s42, s42, 0x10000
    buffer_load_dwordx4 v1, s[20:23], s42 offen nt lds
    s_mov_b32 m0, 6144
    s_add_u32 s42, s42, 0x10000
    buffer_load_dwordx4 v1, s[20:23], s42 offen nt lds
    s_mov_b32 m0, 7168
    s_add_u32 s42, s42, 0x10000
    buffer_load_dwordx4 v1, s[20:23], s42 offen nt lds
    s_mov_b32 m0, 8192
    s_add_u32 s42, s42, 0x10000
    buffer_load_dwordx4 v1, s[20:23], s42 offen nt lds
    s_mov_b32 m0, 9216
    s_add_u32 s42, s42, 0x10000
    buffer_load_dwordx4 v1, s[20:23], s42 offen nt lds
    s_mov_b32 m0, 10240
    s_add_u32 s42, s42, 0x10000
    buffer_load_dwordx4 v1, s[20:23], s42 offen nt lds
    s_mov_b32 m0, 11264
    s_add_u32 s42, s42, 0x10000
    buffer_load_dwordx4 v1, s[20:23], s42 offen nt lds
    s_mov_b32 m0, 12288
    s_add_u32 s42, s42, 0x10000
    buffer_load_dwordx4 v1, s[20:23], s42 offen nt lds
    s_mov_b32 m0, 13312
    s_add_u32 s42, s42, 0x10000
    buffer_load_dwordx4 v1, s[20:23], s42 offen nt lds
    s_mov_b32 m0, 14336
    s_add_u32 s42, s42, 0x10000
    buffer_load_dwordx4 v1, s[20:23], s42 offen nt lds
    s_mov_b32 m0, 15360
    s_add_u32 s42, s42, 0x10000
    buffer_load_dwordx4 v1, s[20:23], s42 offen nt lds
    s_mov_b32 m0, 16384
    s_add_u32 s42, s42, 0x10000
    buffer_load_dwordx4 v1, s[20:23], s42 offen nt lds
    s_mov_b32 m0, 17408
    s_add_u32 s42, s42, 0x10000
    buffer_load_dwordx4 v1, s[20:23], s42 offen nt lds
    s_getpc_b64 s[54:55]
L_pc:
    s_sub_u32 s54, s54, L_pc-standalone__gqa_block_cached__decode_kernel
    s_subb_u32 s55, s55, 0
    v_lshlrev_b32 v14, 7, v0
    global_load_dword v60, v14, s[54:55]
    v_add_u32 v14, 0x2000, v14
    v_cmp_gt_u32 vcc, L_codeend-standalone__gqa_block_cached__decode_kernel, v14
    s_and_saveexec_b64 s[56:57], vcc
    global_load_dword v61, v14, s[54:55]
    s_mov_b64 exec, s[56:57]
    s_mov_b32 s28, s18
    s_mov_b32 s29, s19
    s_mov_b32 s30, 0x10000000
    s_mov_b32 s31, 0x20000
    v_mov_b32 v8, -1
    v_mov_b32 v9, -1
    v_mov_b32 v10, -1
    v_mov_b32 v11, -1
    v_lshlrev_b32 v4, 4, v0
    s_lshr_b32 s44, s32, 2
    s_mul_i32 s44, s44, 8192
    s_add_u32 s44, s44, 1048576
    s_and_b32 s43, s32, 3
    s_lshl_b32 s45, s43, 9
    s_add_u32 s45, s45, s44
    s_lshl_b32 s47, s43, 8
    s_add_u32 s47, s47, s44
    s_mov_b64 exec, 15
    ds_write_b128 v4, v[8:11] offset:53760
    s_mov_b64 exec, -1
    s_mov_b32 s90, 0x07060501
    s_mov_b32 s91, 0x07060100
    s_mov_b32 s92, 0x07060302
    s_mov_b32 s93, 0x05040100
    s_mov_b32 s94, 0x0706000c
    v_bfe_u32 v5, v0, 2, 2
    v_lshlrev_b32 v5, 7, v5
    v_and_b32 v6, 3, v0
    v_lshl_add_u32 v5, v6, 3, v5
    v_lshl_add_u32 v6, v3, 9, v5
    v_lshl_add_u32 v5, v3, 10, v5
    s_mov_b32 s41, 131072
    v_mul_lo_u32 v7, s41, v3
    v_and_b32 v12, 15, v0
    v_lshl_add_u32 v7, v12, 4, v7
    s_lshr_b32 s46, s40, 2
    s_mul_i32 s46, s46, 8192
    s_lshl_b32 s41, s35, 10
    s_add_u32 s46, s46, s41
    s_and_b32 s41, s40, 3
    s_lshl_b32 s41, s41, 8
    s_add_u32 s46, s46, s41
    s_add_u32 s46, s46, 1052672
    s_add_u32 s50, s44, 4096
    v_and_b32 v12, 15, v0
    v_lshlrev_b32 v12, 1, v12
    v_lshl_add_u32 v12, v3, 7, v12
    s_waitcnt lgkmcnt(0)
    s_add_u32 s34, s34, 0x7f4a7c15
    v_mov_b32 v13, s34
    s_getreg_b32 s36, hwreg(HW_REG_XCC_ID, 0, 4)
    s_lshl_b32 s36, s36, 12
    s_add_u32 s36, s36, 65792
    s_and_b32 s37, s2, 7
    s_add_u32 s37, s37, s34
    v_and_b32 v15, 31, v0
    v_lshlrev_b32 v15, 2, v15
    s_waitcnt vmcnt(0)
    buffer_load_dword v14, v15, s[28:31], s36 offen sc1
    ds_read_b64_tr_b16 v[64:65], v5 offset:0
    ds_read_b64_tr_b16 v[66:67], v5 offset:512
    ds_read_b64_tr_b16 v[68:69], v5 offset:4096
    ds_read_b64_tr_b16 v[70:71], v5 offset:4608
    ds_read_b64_tr_b16 v[72:73], v5 offset:8192
    ds_read_b64_tr_b16 v[74:75], v5 offset:8704
    ds_read_b64_tr_b16 v[76:77], v5 offset:12288
    ds_read_b64_tr_b16 v[78:79], v5 offset:12800
    ds_read_b64_tr_b16 v[80:81], v6 offset:16384
    ds_read_b64_tr_b16 v[84:85], v5 offset:32
    ds_read_b64_tr_b16 v[86:87], v5 offset:544
    ds_read_b64_tr_b16 v[88:89], v5 offset:4128
    ds_read_b64_tr_b16 v[90:91], v5 offset:4640
    ds_read_b64_tr_b16 v[92:93], v5 offset:8224
    ds_read_b64_tr_b16 v[94:95], v5 offset:8736
    ds_read_b64_tr_b16 v[96:97], v5 offset:12320
    ds_read_b64_tr_b16 v[98:99], v5 offset:12832
    ds_read_b64_tr_b16 v[100:101], v6 offset:16416
    ds_read_b64_tr_b16 v[104:105], v5 offset:64
    ds_read_b64_tr_b16 v[106:107], v5 offset:576
    ds_read_b64_tr_b16 v[108:109], v5 offset:4160
    ds_read_b64_tr_b16 v[110:111], v5 offset:4672
    ds_read_b64_tr_b16 v[112:113], v5 offset:8256
    ds_read_b64_tr_b16 v[114:115], v5 offset:8768
    ds_read_b64_tr_b16 v[116:117], v5 offset:12352
    ds_read_b64_tr_b16 v[118:119], v5 offset:12864
    ds_read_b64_tr_b16 v[120:121], v6 offset:16448
    ds_read_b64_tr_b16 v[124:125], v5 offset:96
    ds_read_b64_tr_b16 v[126:127], v5 offset:608
    ds_read_b64_tr_b16 v[128:129], v5 offset:4192
    ds_read_b64_tr_b16 v[130:131], v5 offset:4704
    ds_read_b64_tr_b16 v[132:133], v5 offset:8288
    ds_read_b64_tr_b16 v[134:135], v5 offset:8800
    ds_read_b64_tr_b16 v[136:137], v5 offset:12384
    ds_read_b64_tr_b16 v[138:139], v5 offset:12896
    ds_read_b64_tr_b16 v[140:141], v6 offset:16480
    s_waitcnt lgkmcnt(15)
    v_mfma_f32_16x16x32_bf16 v[40:43], v[16:19], v[64:67], 0
    v_mfma_f32_16x16x32_bf16 v[40:43], v[20:23], v[68:71], v[40:43]
    v_mfma_f32_16x16x32_bf16 v[40:43], v[24:27], v[72:75], v[40:43]
    v_mfma_f32_16x16x32_bf16 v[40:43], v[28:31], v[76:79], v[40:43]
    s_waitcnt lgkmcnt(15)
    v_mfma_f32_16x16x32_bf16 v[44:47], v[16:19], v[84:87], 0
    v_mfma_f32_16x16x32_bf16 v[44:47], v[20:23], v[88:91], v[44:47]
    v_mfma_f32_16x16x32_bf16 v[44:47], v[24:27], v[92:95], v[44:47]
    v_mfma_f32_16x16x32_bf16 v[44:47], v[28:31], v[96:99], v[44:47]
    s_waitcnt lgkmcnt(9)
    v_mfma_f32_16x16x32_bf16 v[48:51], v[16:19], v[104:107], 0
    v_mfma_f32_16x16x32_bf16 v[48:51], v[20:23], v[108:111], v[48:51]
    v_mfma_f32_16x16x32_bf16 v[48:51], v[24:27], v[112:115], v[48:51]
    v_mfma_f32_16x16x32_bf16 v[48:51], v[28:31], v[116:119], v[48:51]
    s_waitcnt lgkmcnt(0)
    v_mfma_f32_16x16x32_bf16 v[52:55], v[16:19], v[124:127], 0
    v_mfma_f32_16x16x32_bf16 v[52:55], v[20:23], v[128:131], v[52:55]
    v_mfma_f32_16x16x32_bf16 v[52:55], v[24:27], v[132:135], v[52:55]
    v_mfma_f32_16x16x32_bf16 v[52:55], v[28:31], v[136:139], v[52:55]
    s_nop 3
    v_mfma_f32_16x16x16_bf16 v[40:43], v[32:33], v[80:81], v[40:43]
    v_mfma_f32_16x16x16_bf16 v[44:47], v[32:33], v[100:101], v[44:47]
    v_mfma_f32_16x16x16_bf16 v[48:51], v[32:33], v[120:121], v[48:51]
    v_mfma_f32_16x16x16_bf16 v[52:55], v[32:33], v[140:141], v[52:55]
    s_nop 4
    v_mov_b32_dpp v40, v41 quad_perm:[0,1,2,3] row_mask:0x2 bank_mask:0xf
    v_mov_b32_dpp v40, v42 quad_perm:[0,1,2,3] row_mask:0x4 bank_mask:0xf
    v_mov_b32_dpp v40, v43 quad_perm:[0,1,2,3] row_mask:0x8 bank_mask:0xf
    v_mov_b32_dpp v44, v45 quad_perm:[0,1,2,3] row_mask:0x2 bank_mask:0xf
    v_mov_b32_dpp v44, v46 quad_perm:[0,1,2,3] row_mask:0x4 bank_mask:0xf
    v_mov_b32_dpp v44, v47 quad_perm:[0,1,2,3] row_mask:0x8 bank_mask:0xf
    v_mov_b32_dpp v48, v49 quad_perm:[0,1,2,3] row_mask:0x2 bank_mask:0xf
    v_mov_b32_dpp v48, v50 quad_perm:[0,1,2,3] row_mask:0x4 bank_mask:0xf
    v_mov_b32_dpp v48, v51 quad_perm:[0,1,2,3] row_mask:0x8 bank_mask:0xf
    v_mov_b32_dpp v52, v53 quad_perm:[0,1,2,3] row_mask:0x2 bank_mask:0xf
    v_mov_b32_dpp v52, v54 quad_perm:[0,1,2,3] row_mask:0x4 bank_mask:0xf
    v_mov_b32_dpp v52, v55 quad_perm:[0,1,2,3] row_mask:0x8 bank_mask:0xf
    v_perm_b32 v36, v40, v44, s90
    v_perm_b32 v37, v44, v13, s91
    v_perm_b32 v38, v48, v52, s90
    v_perm_b32 v39, v52, v13, s92
    v_mov_b32 v5, 0
    s_mov_b32 s48, 0
    s_mov_b32 s49, 1
L_rz:
    s_waitcnt vmcnt(0)
    v_cmp_ne_u32 vcc, s37, v14
    s_add_u32 s48, s48, 1
    s_cbranch_vccz L_rzdone
    buffer_load_dword v14, v15, s[28:31], s36 offen sc1
    s_cmp_lt_u32 s48, 4
    s_cbranch_scc1 L_rz
    s_mov_b32 s49, 0
L_rzdone:
    s_cmp_lg_u32 s49, 0
    s_cbranch_scc1 L_pubL1
    buffer_store_dwordx4 v[36:39], v7, s[28:31], s46 offen sc1
    s_mov_b32 exec_hi, 0
    buffer_store_dwordx4 v[8:11], v4, s[28:31], s45 offen sc1
    s_mov_b32 exec_hi, -1
    s_branch L_pubE1
L_pubL1:
    buffer_store_dwordx4 v[36:39], v7, s[28:31], s46 offen
    s_mov_b32 exec_hi, 0
    buffer_store_dwordx4 v[8:11], v4, s[28:31], s45 offen
    s_mov_b32 exec_hi, -1
L_pubE1:
    s_mov_b32 s48, 0
L_qpoll:
    buffer_load_dwordx4 v[16:19], v4, s[28:31], s50 offen offset:0 sc1
    buffer_load_dwordx4 v[20:23], v4, s[28:31], s50 offen offset:1024 sc1
    buffer_load_dwordx4 v[24:27], v4, s[28:31], s50 offen offset:2048 sc1
    buffer_load_dwordx4 v[28:31], v4, s[28:31], s50 offen offset:3072 sc1
    s_add_u32 s48, s48, 1
    s_waitcnt vmcnt(0)
    v_perm_b32 v32, v19, v17, s93
    v_perm_b32 v33, v23, v21, s93
    v_perm_b32 v34, v27, v25, s93
    v_perm_b32 v35, v31, v29, s93
    v_xor_b32 v32, s34, v32
    v_xor_b32 v33, s34, v33
    v_xor_b32 v34, s34, v34
    v_xor_b32 v35, s34, v35
    v_or3_b32 v32, v32, v33, v34
    v_or_b32 v32, v32, v35
    v_cmp_ne_u32 vcc, 0, v32
    s_nop 0
    s_cbranch_vccz L_qok
    s_sleep 2
    s_cmp_lt_u32 s48, 1048576
    s_cbranch_scc1 L_qpoll
L_qok:
    v_perm_b32 v17, v17, v16, s94
    v_perm_b32 v19, v19, v18, s94
    v_and_b32 v16, 0xffffff00, v16
    v_and_b32 v18, 0xffffff00, v18
    v_perm_b32 v21, v21, v20, s94
    v_perm_b32 v23, v23, v22, s94
    v_and_b32 v20, 0xffffff00, v20
    v_and_b32 v22, 0xffffff00, v22
    v_perm_b32 v25, v25, v24, s94
    v_perm_b32 v27, v27, v26, s94
    v_and_b32 v24, 0xffffff00, v24
    v_and_b32 v26, 0xffffff00, v26
    v_perm_b32 v29, v29, v28, s94
    v_perm_b32 v31, v31, v30, s94
    v_and_b32 v28, 0xffffff00, v28
    v_and_b32 v30, 0xffffff00, v30
    v_add_f32 v16, v16, v20
    v_add_f32 v24, v24, v28
    v_add_f32 v17, v17, v21
    v_add_f32 v25, v25, v29
    v_add_f32 v18, v18, v22
    v_add_f32 v26, v26, v30
    v_add_f32 v19, v19, v23
    v_add_f32 v27, v27, v31
    v_add_f32 v16, v16, v24
    v_add_f32 v17, v17, v25
    v_add_f32 v18, v18, v26
    v_add_f32 v19, v19, v27
    v_cvt_pk_bf16_f32 v20, v16, v17
    v_cvt_pk_bf16_f32 v21, v18, v19
    ds_write_b16 v12, v20 offset:53248
    ds_write_b16_d16_hi v12, v20 offset:53280
    ds_write_b16 v12, v21 offset:53312
    ds_write_b16_d16_hi v12, v21 offset:53344
    s_waitcnt lgkmcnt(0)
    s_barrier
    s_mov_b32 s48, 0
L_mlwait:
    s_sleep 64
    ds_read_b128 v[16:19], v5 offset:53760
    ds_read_b128 v[20:23], v5 offset:53776
    ds_read_b128 v[24:27], v5 offset:53792
    ds_read_b128 v[28:31], v5 offset:53808
    s_add_u32 s48, s48, 1
    s_waitcnt lgkmcnt(0)
    v_max3_u32 v32, v16, v17, v18
    v_max3_u32 v32, v32, v19, v20
    v_max3_u32 v32, v32, v21, v22
    v_max3_u32 v32, v32, v23, v24
    v_max3_u32 v32, v32, v25, v26
    v_max3_u32 v32, v32, v27, v28
    v_max3_u32 v32, v32, v29, v30
    v_max_u32 v32, v32, v31
    v_cmp_eq_u32 vcc, -1, v32
    s_nop 0
    s_cbranch_vccz L_mlwait_ok
    s_cmp_lt_u32 s48, 1048576
    s_cbranch_scc1 L_mlwait
L_mlwait_ok:
    s_waitcnt vmcnt(0)
    v_max3_f32 v36, v16, v20, v24
    v_max_f32 v36, v36, v28
    v_sub_f32 v44, v16, v36
    v_exp_f32 v44, v44
    v_sub_f32 v45, v20, v36
    v_exp_f32 v45, v45
    v_sub_f32 v46, v24, v36
    v_exp_f32 v46, v46
    v_sub_f32 v47, v28, v36
    v_exp_f32 v47, v47
    v_mov_b32 v37, s34
    v_mul_f32 v38, v44, v17
    v_fmac_f32 v38, v45, v21
    v_fmac_f32 v38, v46, v25
    v_fmac_f32 v38, v47, v29
    v_mov_b32 v39, s34
    v_max3_f32 v40, v18, v22, v26
    v_max_f32 v40, v40, v30
    v_sub_f32 v44, v18, v40
    v_exp_f32 v44, v44
    v_sub_f32 v45, v22, v40
    v_exp_f32 v45, v45
    v_sub_f32 v46, v26, v40
    v_exp_f32 v46, v46
    v_sub_f32 v47, v30, v40
    v_exp_f32 v47, v47
    v_mov_b32 v41, s34
    v_mul_f32 v42, v44, v19
    v_fmac_f32 v42, v45, v23
    v_fmac_f32 v42, v46, v27
    v_fmac_f32 v42, v47, v31
    v_mov_b32 v43, s34
    s_mov_b64 exec, 1
    s_cmp_lg_u32 s49, 0
    s_cbranch_scc1 L_pubL2
    buffer_store_dwordx4 v[36:39], v5, s[28:31], s47 offen offset:2048 sc1
    buffer_store_dwordx4 v[40:43], v5, s[28:31], s47 offen offset:2064 sc1
    s_branch L_pubE2
L_pubL2:
    buffer_store_dwordx4 v[36:39], v5, s[28:31], s47 offen offset:2048
    buffer_store_dwordx4 v[40:43], v5, s[28:31], s47 offen offset:2064
L_pubE2:
    s_mov_b32 s48, 0
L_gml:
    s_sleep 64
    buffer_load_dwordx4 v[64:67], v5, s[28:31], s44 offen offset:2048 sc1
    buffer_load_dwordx4 v[68:71], v5, s[28:31], s44 offen offset:2064 sc1
    buffer_load_dwordx4 v[72:75], v5, s[28:31], s44 offen offset:2304 sc1
    buffer_load_dwordx4 v[76:79], v5, s[28:31], s44 offen offset:2320 sc1
    buffer_load_dwordx4 v[80:83], v5, s[28:31], s44 offen offset:2560 sc1
    buffer_load_dwordx4 v[84:87], v5, s[28:31], s44 offen offset:2576 sc1
    buffer_load_dwordx4 v[88:91], v5, s[28:31], s44 offen offset:2816 sc1
    buffer_load_dwordx4 v[92:95], v5, s[28:31], s44 offen offset:2832 sc1
    s_add_u32 s48, s48, 1
    s_waitcnt vmcnt(0)
    v_mov_b32 v32, 0
    v_xor_b32 v33, s34, v65
    v_xor_b32 v34, s34, v67
    v_or3_b32 v32, v32, v33, v34
    v_xor_b32 v33, s34, v69
    v_xor_b32 v34, s34, v71
    v_or3_b32 v32, v32, v33, v34
    v_xor_b32 v33, s34, v73
    v_xor_b32 v34, s34, v75
    v_or3_b32 v32, v32, v33, v34
    v_xor_b32 v33, s34, v77
    v_xor_b32 v34, s34, v79
    v_or3_b32 v32, v32, v33, v34
    v_xor_b32 v33, s34, v81
    v_xor_b32 v34, s34, v83
    v_or3_b32 v32, v32, v33, v34
    v_xor_b32 v33, s34, v85
    v_xor_b32 v34, s34, v87
    v_or3_b32 v32, v32, v33, v34
    v_xor_b32 v33, s34, v89
    v_xor_b32 v34, s34, v91
    v_or3_b32 v32, v32, v33, v34
    v_xor_b32 v33, s34, v93
    v_xor_b32 v34, s34, v95
    v_or3_b32 v32, v32, v33, v34
    v_cmp_ne_u32 vcc, 0, v32
    s_nop 0
    s_cbranch_vccz L_gmlok
    s_cmp_lt_u32 s48, 1048576
    s_cbranch_scc1 L_gml
L_gmlok:
    v_max3_f32 v36, v64, v72, v80
    v_max_f32 v36, v36, v88
    v_sub_f32 v44, v64, v36
    v_exp_f32 v44, v44
    v_sub_f32 v45, v72, v36
    v_exp_f32 v45, v45
    v_sub_f32 v46, v80, v36
    v_exp_f32 v46, v46
    v_sub_f32 v47, v88, v36
    v_exp_f32 v47, v47
    s_nop 0
    v_mul_f32 v37, v44, v66
    v_fmac_f32 v37, v45, v74
    v_fmac_f32 v37, v46, v82
    v_fmac_f32 v37, v47, v90
    v_rcp_f32 v37, v37
    v_sub_f32 v44, v16, v36
    v_exp_f32 v44, v44
    v_sub_f32 v45, v20, v36
    v_exp_f32 v45, v45
    v_sub_f32 v46, v24, v36
    v_exp_f32 v46, v46
    v_sub_f32 v47, v28, v36
    v_exp_f32 v47, v47
    s_nop 0
    v_mul_f32 v44, v44, v37
    v_mul_f32 v45, v45, v37
    v_mul_f32 v46, v46, v37
    v_mul_f32 v47, v47, v37
    s_nop 0
    v_readfirstlane_b32 s50, v44
    v_readfirstlane_b32 s52, v45
    v_readfirstlane_b32 s54, v46
    v_readfirstlane_b32 s56, v47
    v_max3_f32 v36, v68, v76, v84
    v_max_f32 v36, v36, v92
    v_sub_f32 v44, v68, v36
    v_exp_f32 v44, v44
    v_sub_f32 v45, v76, v36
    v_exp_f32 v45, v45
    v_sub_f32 v46, v84, v36
    v_exp_f32 v46, v46
    v_sub_f32 v47, v92, v36
    v_exp_f32 v47, v47
    s_nop 0
    v_mul_f32 v37, v44, v70
    v_fmac_f32 v37, v45, v78
    v_fmac_f32 v37, v46, v86
    v_fmac_f32 v37, v47, v94
    v_rcp_f32 v37, v37
    v_sub_f32 v44, v18, v36
    v_exp_f32 v44, v44
    v_sub_f32 v45, v22, v36
    v_exp_f32 v45, v45
    v_sub_f32 v46, v26, v36
    v_exp_f32 v46, v46
    v_sub_f32 v47, v30, v36
    v_exp_f32 v47, v47
    s_nop 0
    v_mul_f32 v44, v44, v37
    v_mul_f32 v45, v45, v37
    v_mul_f32 v46, v46, v37
    v_mul_f32 v47, v47, v37
    s_nop 0
    v_readfirstlane_b32 s51, v44
    v_readfirstlane_b32 s53, v45
    v_readfirstlane_b32 s55, v46
    v_readfirstlane_b32 s57, v47
    s_cmp_ge_u32 s2, 144
    s_cbranch_scc1 L_wrdy_ok
    s_mov_b64 exec, 0xffff
    s_lshr_b32 s41, s2, 3
    s_and_b32 s40, s2, 7
    s_cmp_ge_u32 s41, 9
    s_cselect_b32 s95, 8, 0
    s_add_u32 s40, s40, s95
    s_cmp_ge_u32 s41, 9
    s_cselect_b32 s95, 9, 0
    s_sub_u32 s41, s41, s95
    s_mul_i32 s40, s40, 8192
    s_add_u32 s40, s40, 1050628
    s_mov_b32 s41, 131072
    v_lshrrev_b32 v6, 2, v0
    v_mul_lo_u32 v6, s41, v6
    v_and_b32 v7, 3, v0
    v_lshl_add_u32 v6, v7, 8, v6
    s_mov_b32 s48, 0
L_wrdy:
    s_sleep 64
    buffer_load_dword v8, v6, s[28:31], s40 offen sc1
    s_add_u32 s48, s48, 1
    s_waitcnt vmcnt(0)
    v_cmp_ne_u32 vcc, s34, v8
    s_nop 0
    s_cbranch_vccz L_wrdy_ok
    s_cmp_lt_u32 s48, 1048576
    s_cbranch_scc1 L_wrdy
L_wrdy_ok:
    s_mov_b64 exec, -1
    v_lshlrev_b32 v5, 3, v0
    s_mov_b32 s48, 0x55555555
    s_setprio 3
    s_barrier
    ds_read_b128 v[16:19], v4 offset:54272
    ds_read_b128 v[20:23], v4 offset:55296
    ds_read_b128 v[24:27], v4 offset:56320
    ds_read_b128 v[28:31], v4 offset:57344
    s_waitcnt lgkmcnt(3)
    v_mul_f32 v32, s50, v16
    v_mul_f32 v33, s51, v17
    v_mul_f32 v34, s50, v18
    v_mul_f32 v35, s51, v19
    s_waitcnt lgkmcnt(2)
    v_fmac_f32 v32, s52, v20
    v_fmac_f32 v33, s53, v21
    v_fmac_f32 v34, s52, v22
    v_fmac_f32 v35, s53, v23
    s_waitcnt lgkmcnt(1)
    v_fmac_f32 v32, s54, v24
    v_fmac_f32 v33, s55, v25
    v_fmac_f32 v34, s54, v26
    v_fmac_f32 v35, s55, v27
    s_waitcnt lgkmcnt(0)
    v_fmac_f32 v32, s56, v28
    v_fmac_f32 v33, s57, v29
    v_fmac_f32 v34, s56, v30
    v_fmac_f32 v35, s57, v31
    v_cvt_pk_bf16_f32 v36, v32, v34
    v_cvt_pk_bf16_f32 v37, v33, v35
    v_min_u32 v36, 0xfffffffe, v36
    v_min_u32 v37, 0xfffffffe, v37
    s_nop 0
    v_mov_b32_dpp v38, v36 quad_perm:[1,1,3,3] row_mask:0xf bank_mask:0xf
    v_mov_b32_dpp v39, v37 quad_perm:[1,1,3,3] row_mask:0xf bank_mask:0xf
    s_mov_b32 exec_lo, s48
    s_mov_b32 exec_hi, s48
    s_cmp_lg_u32 s49, 0
    s_cbranch_scc1 L_pubL3
    buffer_store_dwordx4 v[36:39], v5, s[28:31], s45 offen sc1
    s_branch L_pubE3
L_pubL3:
    buffer_store_dwordx4 v[36:39], v5, s[28:31], s45 offen
L_pubE3:
    s_barrier
    s_cmp_ge_u32 s2, 144
    s_cbranch_scc1 L_hdone
    s_barrier
    s_barrier
L_hdone:
    s_endpgm
L_balancer:
    s_getreg_b32 s40, hwreg(HW_REG_XCC_ID, 0, 4)
    v_lshlrev_b32 v1, 2, v0
    v_lshlrev_b32 v2, 4, v0
    v_mov_b32 v4, 0
    v_mov_b32 v5, 0
    v_mov_b32 v6, 0
    v_mov_b32 v7, 0
    ds_write_b128 v2, v[4:7] offset:59392
    ds_write_b128 v2, v[4:7] offset:58368
    s_waitcnt lgkmcnt(0)
    s_load_dword s34, s[18:19], 0
    s_mov_b32 s28, s18
    s_mov_b32 s29, s19
    s_mov_b32 s30, 0x10000000
    s_mov_b32 s31, 0x20000
    s_mul_i32 s46, s40, 4352
    s_add_u32 s46, s46, 131072
    s_lshl_b32 s40, s40, 12
    s_add_u32 s40, s40, 65536
    s_lshr_b32 s41, s2, 3
    s_lshl_b32 s41, s41, 2
    v_mov_b32 v3, s41
    s_mov_b32 s48, 0
    s_waitcnt lgkmcnt(0)
    s_add_u32 s34, s34, 0x7f4a7c15
    s_and_b32 s41, s2, 7
    s_add_u32 s41, s41, s34
    v_mov_b32 v8, s41
    s_mov_b64 exec, 1
    buffer_store_dword v8, v3, s[28:31], s40 offen offset:256
    s_mov_b64 exec, -1
    s_mov_b32 s60, 72
    s_mov_b32 s72, -1
    s_mov_b32 s80, 0
    s_mov_b32 s73, -1
    s_mov_b32 s81, 0
    s_mov_b32 s74, -1
    s_mov_b32 s82, 0
    s_mov_b32 s75, -1
    s_mov_b32 s83, 0
    s_mov_b32 s76, -1
    s_mov_b32 s84, 0
    s_mov_b32 s77, -1
    s_mov_b32 s85, 0
    s_mov_b32 s78, -1
    s_mov_b32 s86, 0
    s_mov_b32 s79, -1
    s_mov_b32 s87, 0
    s_cmp_lt_u32 s2, 144
    s_cselect_b32 s61, 9, 9
    s_lshl_b32 s34, s34, 16
    s_barrier
L_bal:
    s_sleep 1
    ds_read2st64_b32 v[8:9], v4 offset0:228 offset1:229
    ds_read2st64_b32 v[10:11], v4 offset0:230 offset1:231
    s_add_u32 s48, s48, 1
    s_waitcnt lgkmcnt(0)
    v_add3_u32 v8, v8, v9, v10
    v_add_u32 v8, v8, v11
    v_or_b32 v9, s34, v8
    v_readfirstlane_b32 s42, v8
    s_mov_b64 exec, 1
    buffer_store_dword v9, v3, s[28:31], s40 offen
    s_mov_b64 exec, -1
    s_cmp_ge_u32 s42, 992
    s_cbranch_scc1 L_end
    s_cmp_ge_u32 s2, 8
    s_cbranch_scc1 L_nosl
    s_load_dword s64, s[18:19], 131072 glc
    s_load_dword s65, s[18:19], 135424 glc
    s_load_dword s66, s[18:19], 139776 glc
    s_load_dword s67, s[18:19], 144128 glc
    s_load_dword s68, s[18:19], 148480 glc
    s_load_dword s69, s[18:19], 152832 glc
    s_load_dword s70, s[18:19], 157184 glc
    s_load_dword s71, s[18:19], 161536 glc
L_nosl:
    v_mov_b32 v10, 0
    s_mov_b32 exec_hi, 1
    buffer_load_dword v10, v1, s[28:31], s40 offen sc1
    s_mov_b32 exec_hi, -1
    s_waitcnt vmcnt(0)
    v_xor_b32 v10, s34, v10
    v_add_u32 v11, -1, v10
    v_cmp_gt_u32 vcc, 0xffff, v11
    s_nop 1
    v_cndmask_b32 v10, 0, v10, vcc
    s_bcnt1_i32_b32 s43, vcc_lo
    s_nop 1
    v_add_u32_dpp v10, v10, v10 row_ror:1 row_mask:0xf bank_mask:0xf
    s_nop 1
    v_add_u32_dpp v10, v10, v10 row_ror:2 row_mask:0xf bank_mask:0xf
    s_nop 1
    v_add_u32_dpp v10, v10, v10 row_ror:4 row_mask:0xf bank_mask:0xf
    s_nop 1
    v_add_u32_dpp v10, v10, v10 row_ror:8 row_mask:0xf bank_mask:0xf
    s_lshl_b32 s43, s43, 2
    v_cvt_f32_u32 v12, s43
    v_readlane_b32 s44, v10, 0
    v_readlane_b32 s45, v10, 16
    v_rcp_f32 v12, v12
    s_add_u32 s44, s44, s45
    v_cvt_f32_u32 v13, s44
    v_mul_f32 v13, v13, v12
    v_cvt_u32_f32 v16, v13
    v_add_u32 v12, s61, v16
    v_readlane_b32 s45, v10, 32
    s_cmp_eq_u32 s45, 0
    s_cselect_b32 s45, 32, s45
    s_sub_u32 s45, s45, 32
    v_add_u32 v12, s45, v12
    v_mov_b32 v13, v12
    v_mov_b32 v14, v12
    v_mov_b32 v15, v12
    ds_write_b128 v2, v[12:15] offset:59392
    s_cmp_ge_u32 s2, 8
    s_cbranch_scc1 L_balnext
    v_readfirstlane_b32 s47, v16
    v_or_b32 v17, s34, v16
    s_mov_b64 exec, 1
    s_cmp_lt_u32 s47, s60
    s_cbranch_scc1 L_nopub
    buffer_store_dword v17, v4, s[28:31], s46 offen sc1
    s_add_u32 s60, s60, 40
L_nopub:
    s_mov_b32 s43, 0
    s_mov_b32 s44, 0
    s_waitcnt lgkmcnt(0)
    s_xor_b32 s64, s64, s34
    s_or_b32 s43, s43, s64
    s_sub_i32 s45, s64, s47
    s_cmp_lg_u32 s64, s72
    s_cselect_b32 s80, s45, s80
    s_mov_b32 s72, s64
    s_add_i32 s44, s44, s80
    s_xor_b32 s65, s65, s34
    s_or_b32 s43, s43, s65
    s_sub_i32 s45, s65, s47
    s_cmp_lg_u32 s65, s73
    s_cselect_b32 s81, s45, s81
    s_mov_b32 s73, s65
    s_add_i32 s44, s44, s81
    s_xor_b32 s66, s66, s34
    s_or_b32 s43, s43, s66
    s_sub_i32 s45, s66, s47
    s_cmp_lg_u32 s66, s74
    s_cselect_b32 s82, s45, s82
    s_mov_b32 s74, s66
    s_add_i32 s44, s44, s82
    s_xor_b32 s67, s67, s34
    s_or_b32 s43, s43, s67
    s_sub_i32 s45, s67, s47
    s_cmp_lg_u32 s67, s75
    s_cselect_b32 s83, s45, s83
    s_mov_b32 s75, s67
    s_add_i32 s44, s44, s83
    s_xor_b32 s68, s68, s34
    s_or_b32 s43, s43, s68
    s_sub_i32 s45, s68, s47
    s_cmp_lg_u32 s68, s76
    s_cselect_b32 s84, s45, s84
    s_mov_b32 s76, s68
    s_add_i32 s44, s44, s84
    s_xor_b32 s69, s69, s34
    s_or_b32 s43, s43, s69
    s_sub_i32 s45, s69, s47
    s_cmp_lg_u32 s69, s77
    s_cselect_b32 s85, s45, s85
    s_mov_b32 s77, s69
    s_add_i32 s44, s44, s85
    s_xor_b32 s70, s70, s34
    s_or_b32 s43, s43, s70
    s_sub_i32 s45, s70, s47
    s_cmp_lg_u32 s70, s78
    s_cselect_b32 s86, s45, s86
    s_mov_b32 s78, s70
    s_add_i32 s44, s44, s86
    s_xor_b32 s71, s71, s34
    s_or_b32 s43, s43, s71
    s_sub_i32 s45, s71, s47
    s_cmp_lg_u32 s71, s79
    s_cselect_b32 s87, s45, s87
    s_mov_b32 s79, s71
    s_add_i32 s44, s44, s87
    s_ashr_i32 s44, s44, 3
    s_add_i32 s44, s44, 11
    s_max_i32 s44, s44, -12
    s_min_i32 s44, s44, 12
    s_add_i32 s44, s44, 32
    s_cmp_lt_u32 s43, 0x10000
    s_cselect_b32 s44, s44, 0
    s_or_b32 s44, s44, s34
    v_mov_b32 v17, s44
    buffer_store_dword v17, v4, s[28:31], s40 offen offset:128
    s_mov_b64 exec, -1
L_balnext:
    s_cmp_lt_u32 s48, 1048576
    s_cbranch_scc1 L_bal
    s_endpgm
L_end:
    s_endpgm
L_codeend:
.section .rodata,"a"
.p2align 6
.amdhsa_kernel standalone__gqa_block_cached__decode_kernel
      .amdhsa_next_free_vgpr 248
      .amdhsa_next_free_sgpr 96
      .amdhsa_accum_offset 248
      .amdhsa_group_segment_fixed_size 0
      .amdhsa_kernarg_size 64
      .amdhsa_user_sgpr_count 2
      .amdhsa_user_sgpr_kernarg_segment_ptr 1
      .amdhsa_system_sgpr_workgroup_id_x 1
.end_amdhsa_kernel
```
